```python
import torch

def _softmax(x, axis=-1):
    return torch.softmax(x, dim=axis)

def _gelu(x):
    return torch.nn.functional.gelu(x, approximate='tanh')

def _silu(x):
    return torch.nn.functional.silu(x)

def _sigmoid(x):
    return torch.sigmoid(x)

def _layernorm(x, axis=-1, eps=1e-05):
    m = x.mean(dim=axis, keepdim=True)
    v = x.var(dim=axis, keepdim=True, unbiased=False)
    return (x - m) / torch.sqrt(v + eps)

def _scatter_add(tgt, idx, src, axis=0):
    return tgt.clone().index_add_(axis, idx, src)

def _segment_sum(src, seg, n):
    out = torch.zeros((n,) + src.shape[1:], dtype=src.dtype)
    return out.index_add_(0, seg, src)

def _pad(x, pw):
    flat = tuple((v for pair in reversed(pw) for v in pair))
    return torch.nn.functional.pad(x, flat)
kernel_name = 'standalone__factorization_afm__recsys'

def setup_inputs():

    _w = lambda a: (lambda t: t.to(torch.bfloat16) if t.is_floating_point() else t)(torch.as_tensor(a))
    B, F, D, V = (4096, 26, 128, min(1000, 100000))
    A = D
    ii, jj = tuple(torch.triu_indices(F, F, 1).unbind(0))
    return {'idx': _w((lambda lo, hi, *s: torch.randint(lo, hi, s))(0, V, B, F).to(torch.int64)), 'table': _w((lambda *s: torch.randn(*s, dtype=torch.bfloat16) * 0.2)(V, D)), 'ii': _w(ii.to(torch.int64)), 'jj': _w(jj.to(torch.int64)), 'W': _w((lambda *s: torch.randn(*s, dtype=torch.bfloat16) * 1.6)(D, A) * (1.0 / D ** 0.5)), 'b': _w((lambda *s: torch.randn(*s, dtype=torch.bfloat16) * 1.6)(A)), 'h': _w((lambda *s: torch.randn(*s, dtype=torch.bfloat16) * 1.6)(A)), 'p': _w((lambda *s: torch.randn(*s, dtype=torch.bfloat16) * 0.2)(D))}

def reference(idx, table, ii, jj, W, b, h, p):
    emb = table[idx]
    ei = emb[:, ii, :].clone()
    ej = emb[:, jj, :].clone()
    pair = ei * ej
    hid = pair @ W + b
    hid = 0.5 * (hid + torch.abs(hid))
    e = hid @ h
    alpha = _softmax(e, axis=-1)
    pooled = torch.einsum('bp,bpd->bd', alpha, pair)
    return pooled @ p
```

```asm
; @launch kernel=afm_tab_kernel grid=(256,1,1) block=(512,1,1) lds=163840
; @launch kernel=afm_out_kernel grid=(512,1,1) block=(256,1,1) lds=0
.amdgcn_target "amdgcn-amd-amdhsa--gfx950"
.text
.globl afm_tab_kernel
.globl afm_out_kernel
.p2align 8
.type afm_tab_kernel,@function
afm_tab_kernel:
    s_cmp_ge_u32 s2, 256
    s_cbranch_scc1 afm_tab_kernel_done
    s_load_dwordx2 s[4:5], s[0:1], 8
    s_load_dwordx8 s[8:15], s[0:1], 32
    s_load_dwordx2 s[6:7], s[0:1], 80
    s_load_dwordx2 s[52:53], s[0:1], 0
    v_lshrrev_b32 v1, 6, v0
    v_and_b32 v0, 63, v0
    v_readfirstlane_b32 s3, v1
    s_lshr_b32 s41, s2, 3
    s_and_b32 s42, s2, 7
    s_cmp_lt_u32 s41, 6
    s_cselect_b32 s43, 0, 1
    s_or_b32 s43, s43, s42
    s_cmp_lg_u32 s43, 0
    s_cbranch_scc1 afm_tab_kernel_cons
    s_waitcnt lgkmcnt(0)
    s_lshl_b32 s46, s3, 6
    v_add_u32 v1, s46, v0
    v_lshlrev_b32 v2, 4, v1
    s_mov_b32 s56, s52
    s_mov_b32 s57, s53
    s_mov_b32 s58, 425984
    s_mov_b32 s59, 0x00020000
    s_mul_i32 s60, s41, 71032
    buffer_load_dwordx4 v[16:19], v2, s[56:59], s60 offen
    s_add_u32 s60, s60, 8192
    buffer_load_dwordx4 v[20:23], v2, s[56:59], s60 offen
    s_add_u32 s60, s60, 8192
    buffer_load_dwordx4 v[24:27], v2, s[56:59], s60 offen
    s_add_u32 s60, s60, 8192
    buffer_load_dwordx4 v[28:31], v2, s[56:59], s60 offen
    s_add_u32 s60, s60, 8192
    buffer_load_dwordx4 v[32:35], v2, s[56:59], s60 offen
    s_add_u32 s60, s60, 8192
    buffer_load_dwordx4 v[36:39], v2, s[56:59], s60 offen
    s_add_u32 s60, s60, 8192
    buffer_load_dwordx4 v[40:43], v2, s[56:59], s60 offen
    s_add_u32 s60, s60, 8192
    buffer_load_dwordx4 v[44:47], v2, s[56:59], s60 offen
    s_add_u32 s60, s60, 8192
    buffer_load_dwordx4 v[48:51], v2, s[56:59], s60 offen
    s_branch afm_tab_kernel_prod
afm_tab_kernel_cons:
    s_and_b32 s43, s42, 3
    s_lshl2_add_u32 s43, s41, s43
    s_add_u32 s41, s41, 1
    s_min_u32 s41, s41, 6
    s_sub_u32 s40, s43, s41
    s_add_u32 s40, s40, 128
    s_bitcmp1_b32 s42, 2
    s_cselect_b32 s40, s43, s40
    s_cmp_lt_u32 s40, 124
    s_cselect_b32 s85, 7, 64
    s_lshl_b32 s40, s40, 2
    v_lshrrev_b32 v2, 4, v0
    v_and_b32 v3, 15, v0
    v_lshlrev_b32 v4, 1, v2
    v_xor_b32 v4, v3, v4
    v_lshlrev_b32 v4, 4, v4
    v_lshl_add_u32 v4, v2, 8, v4
    v_xor_b32 v5, 128, v4
    s_lshl_b32 s41, s3, 12
    s_add_u32 s44, s41, 131072
    s_waitcnt lgkmcnt(0)
    s_mov_b32 s20, s8
    s_mov_b32 s21, s9
    s_mov_b32 s22, 32768
    s_mov_b32 s23, 0x00020000
    s_mov_b32 s36, s6
    s_mov_b32 s37, s7
    s_mov_b32 s38, 0x10000000
    s_mov_b32 s39, 0x00020000
    s_cmp_lg_u32 s3, 4
    s_cbranch_scc1 afm_tab_kernel_nosmall
    s_mov_b32 s24, s10
    s_mov_b32 s25, s11
    s_mov_b32 s26, 256
    s_mov_b32 s27, 0x00020000
    s_mov_b32 s28, s12
    s_mov_b32 s29, s13
    s_mov_b32 s30, 256
    s_mov_b32 s31, 0x00020000
    s_mov_b32 s32, s14
    s_mov_b32 s33, s15
    s_mov_b32 s34, 256
    s_mov_b32 s35, 0x00020000
    v_lshlrev_b32 v9, 4, v0
    s_mov_b64 exec, 0xffff
    s_mov_b32 m0, 130048
    s_nop 0
    buffer_load_dwordx4 v9, s[28:31], 0 offen lds
    s_mov_b32 m0, 130304
    s_nop 0
    buffer_load_dwordx4 v9, s[24:27], 0 offen lds
    s_mov_b32 m0, 130560
    s_nop 0
    buffer_load_dwordx4 v9, s[32:35], 0 offen lds
    s_mov_b64 exec, -1
afm_tab_kernel_nosmall:
    s_add_u32 m0, s44, 0
    s_add_u32 s46, s41, 0
    buffer_load_dwordx4 v4, s[20:23], s46 offen lds
    s_add_u32 m0, s44, 1024
    s_add_u32 s46, s41, 1024
    buffer_load_dwordx4 v4, s[20:23], s46 offen lds
    s_add_u32 m0, s44, 2048
    s_add_u32 s46, s41, 2048
    buffer_load_dwordx4 v5, s[20:23], s46 offen lds
    s_add_u32 m0, s44, 3072
    s_add_u32 s46, s41, 3072
    buffer_load_dwordx4 v5, s[20:23], s46 offen lds
    s_cmp_ge_u32 s3, 4
    s_cbranch_scc1 afm_tab_kernel_helper
    s_mov_b32 s16, s4
    s_mov_b32 s17, s5
    s_mov_b32 s18, 256000
    s_mov_b32 s19, 0x00020000
    s_add_u32 s46, s40, s3
    s_lshl_b32 s46, s46, 8
    v_lshlrev_b32 v9, 4, v2
    buffer_load_dwordx4 v[32:35], v9, s[16:19], s46 offen offset:0
    buffer_load_dwordx4 v[36:39], v9, s[16:19], s46 offen offset:64
    buffer_load_dwordx4 v[40:43], v9, s[16:19], s46 offen offset:128
    buffer_load_dwordx4 v[44:47], v9, s[16:19], s46 offen offset:192
    s_cmp_lg_u32 s3, 0
    s_cbranch_scc1 afm_tab_kernel_noinit
    v_lshlrev_b32 v9, 2, v0
    v_add_u32 v9, 130816, v9
    v_mov_b32 v10, 0
    ds_write_b32 v9, v10
afm_tab_kernel_noinit:
    v_lshrrev_b32 v8, 2, v3
    v_and_b32 v9, 3, v3
    v_lshl_add_u32 v10, v2, 3, v8
    v_lshlrev_b32 v10, 8, v10
    v_lshl_add_u32 v10, v9, 3, v10
    v_and_b32 v11, 1, v2
    v_lshl_add_u32 v11, v11, 2, v8
    v_lshl_add_u32 v10, v11, 5, v10
    v_add_u32 v4, 131072, v10
    v_xor_b32 v5, 32, v4
    v_xor_b32 v6, 64, v4
    v_xor_b32 v7, 96, v4
    v_xor_b32 v8, 128, v4
    v_xor_b32 v9, 160, v4
    v_xor_b32 v10, 192, v4
    v_xor_b32 v11, 224, v4
    v_and_b32 v13, 1, v0
    v_lshlrev_b32 v13, 4, v13
    v_mov_b32 v14, 0xffff
    v_lshlrev_b32 v13, v13, v14
    v_and_b32 v14, 2, v0
    v_cmp_eq_u32 vcc, 0, v14
    v_mov_b32 v15, 0
    s_nop 0
    v_cndmask_b32 v14, v15, v13, vcc
    v_cndmask_b32 v13, v13, v15, vcc
    s_waitcnt vmcnt(0) lgkmcnt(0)
    v_and_b32 v32, v32, v14
    v_and_b32 v33, v33, v13
    v_and_b32 v34, v34, v14
    v_and_b32 v35, v35, v13
    v_and_b32 v36, v36, v14
    v_and_b32 v37, v37, v13
    v_and_b32 v38, v38, v14
    v_and_b32 v39, v39, v13
    v_and_b32 v40, v40, v14
    v_and_b32 v41, v41, v13
    v_and_b32 v42, v42, v14
    v_and_b32 v43, v43, v13
    v_and_b32 v44, v44, v14
    v_and_b32 v45, v45, v13
    v_and_b32 v46, v46, v14
    v_and_b32 v47, v47, v13
    s_barrier
    ds_read_b64_tr_b16 v[128:129], v4 offset:0
    ds_read_b64_tr_b16 v[130:131], v4 offset:1024
    ds_read_b64_tr_b16 v[132:133], v4 offset:8192
    ds_read_b64_tr_b16 v[134:135], v4 offset:9216
    ds_read_b64_tr_b16 v[136:137], v4 offset:16384
    ds_read_b64_tr_b16 v[138:139], v4 offset:17408
    ds_read_b64_tr_b16 v[140:141], v4 offset:24576
    ds_read_b64_tr_b16 v[142:143], v4 offset:25600
    ds_read_b64_tr_b16 v[144:145], v5 offset:0
    ds_read_b64_tr_b16 v[146:147], v5 offset:1024
    ds_read_b64_tr_b16 v[148:149], v5 offset:8192
    ds_read_b64_tr_b16 v[150:151], v5 offset:9216
    ds_read_b64_tr_b16 v[152:153], v5 offset:16384
    ds_read_b64_tr_b16 v[154:155], v5 offset:17408
    ds_read_b64_tr_b16 v[156:157], v5 offset:24576
    s_waitcnt lgkmcnt(11)
    v_mfma_f32_4x4x4_16b_bf16 v[16:19], v[32:33], v[128:129], 0
    v_mfma_f32_4x4x4_16b_bf16 v[20:23], v[34:35], v[130:131], 0
    v_mfma_f32_4x4x4_16b_bf16 v[24:27], v[36:37], v[132:133], 0
    v_mfma_f32_4x4x4_16b_bf16 v[28:31], v[38:39], v[134:135], 0
    s_nop 1
    v_cvt_pk_bf16_f32 v128, v16, v17
    v_cvt_pk_bf16_f32 v129, v18, v19
    ds_read_b64_tr_b16 v[158:159], v5 offset:25600
    ds_read_b64_tr_b16 v[160:161], v6 offset:0
    ds_read_b64_tr_b16 v[162:163], v6 offset:1024
    ds_read_b64_tr_b16 v[164:165], v6 offset:8192
    s_waitcnt lgkmcnt(11)
    v_mfma_f32_4x4x4_16b_bf16 v[16:19], v[40:41], v[136:137], 0
    v_cvt_pk_bf16_f32 v130, v20, v21
    v_cvt_pk_bf16_f32 v131, v22, v23
    v_mfma_f32_4x4x4_16b_bf16 v[20:23], v[42:43], v[138:139], 0
    v_cvt_pk_bf16_f32 v132, v24, v25
    v_cvt_pk_bf16_f32 v133, v26, v27
    v_mfma_f32_4x4x4_16b_bf16 v[24:27], v[44:45], v[140:141], 0
    v_cvt_pk_bf16_f32 v134, v28, v29
    v_cvt_pk_bf16_f32 v135, v30, v31
    v_mfma_f32_4x4x4_16b_bf16 v[28:31], v[46:47], v[142:143], 0
    v_cvt_pk_bf16_f32 v136, v16, v17
    v_cvt_pk_bf16_f32 v137, v18, v19
    ds_read_b64_tr_b16 v[166:167], v6 offset:9216
    ds_read_b64_tr_b16 v[168:169], v6 offset:16384
    ds_read_b64_tr_b16 v[170:171], v6 offset:17408
    ds_read_b64_tr_b16 v[172:173], v6 offset:24576
    s_waitcnt lgkmcnt(11)
    v_mfma_f32_4x4x4_16b_bf16 v[16:19], v[32:33], v[144:145], 0
    v_cvt_pk_bf16_f32 v138, v20, v21
    v_cvt_pk_bf16_f32 v139, v22, v23
    v_mfma_f32_4x4x4_16b_bf16 v[20:23], v[34:35], v[146:147], 0
    v_cvt_pk_bf16_f32 v140, v24, v25
    v_cvt_pk_bf16_f32 v141, v26, v27
    v_mfma_f32_4x4x4_16b_bf16 v[24:27], v[36:37], v[148:149], 0
    v_cvt_pk_bf16_f32 v142, v28, v29
    v_cvt_pk_bf16_f32 v143, v30, v31
    v_mfma_f32_4x4x4_16b_bf16 v[28:31], v[38:39], v[150:151], 0
    v_cvt_pk_bf16_f32 v144, v16, v17
    v_cvt_pk_bf16_f32 v145, v18, v19
    ds_read_b64_tr_b16 v[174:175], v6 offset:25600
    ds_read_b64_tr_b16 v[176:177], v7 offset:0
    ds_read_b64_tr_b16 v[178:179], v7 offset:1024
    ds_read_b64_tr_b16 v[180:181], v7 offset:8192
    s_waitcnt lgkmcnt(11)
    v_mfma_f32_4x4x4_16b_bf16 v[16:19], v[40:41], v[152:153], 0
    v_cvt_pk_bf16_f32 v146, v20, v21
    v_cvt_pk_bf16_f32 v147, v22, v23
    v_mfma_f32_4x4x4_16b_bf16 v[20:23], v[42:43], v[154:155], 0
    v_cvt_pk_bf16_f32 v148, v24, v25
    v_cvt_pk_bf16_f32 v149, v26, v27
    v_mfma_f32_4x4x4_16b_bf16 v[24:27], v[44:45], v[156:157], 0
    v_cvt_pk_bf16_f32 v150, v28, v29
    v_cvt_pk_bf16_f32 v151, v30, v31
    v_mfma_f32_4x4x4_16b_bf16 v[28:31], v[46:47], v[158:159], 0
    v_cvt_pk_bf16_f32 v152, v16, v17
    v_cvt_pk_bf16_f32 v153, v18, v19
    ds_read_b64_tr_b16 v[182:183], v7 offset:9216
    ds_read_b64_tr_b16 v[184:185], v7 offset:16384
    ds_read_b64_tr_b16 v[186:187], v7 offset:17408
    ds_read_b64_tr_b16 v[188:189], v7 offset:24576
    s_waitcnt lgkmcnt(11)
    v_mfma_f32_4x4x4_16b_bf16 v[16:19], v[32:33], v[160:161], 0
    v_cvt_pk_bf16_f32 v154, v20, v21
    v_cvt_pk_bf16_f32 v155, v22, v23
    v_mfma_f32_4x4x4_16b_bf16 v[20:23], v[34:35], v[162:163], 0
    v_cvt_pk_bf16_f32 v156, v24, v25
    v_cvt_pk_bf16_f32 v157, v26, v27
    v_mfma_f32_4x4x4_16b_bf16 v[24:27], v[36:37], v[164:165], 0
    v_cvt_pk_bf16_f32 v158, v28, v29
    v_cvt_pk_bf16_f32 v159, v30, v31
    v_mfma_f32_4x4x4_16b_bf16 v[28:31], v[38:39], v[166:167], 0
    v_cvt_pk_bf16_f32 v160, v16, v17
    v_cvt_pk_bf16_f32 v161, v18, v19
    ds_read_b64_tr_b16 v[190:191], v7 offset:25600
    ds_read_b64_tr_b16 v[192:193], v8 offset:0
    ds_read_b64_tr_b16 v[194:195], v8 offset:1024
    ds_read_b64_tr_b16 v[196:197], v8 offset:8192
    s_waitcnt lgkmcnt(11)
    v_mfma_f32_4x4x4_16b_bf16 v[16:19], v[40:41], v[168:169], 0
    v_cvt_pk_bf16_f32 v162, v20, v21
    v_cvt_pk_bf16_f32 v163, v22, v23
    v_mfma_f32_4x4x4_16b_bf16 v[20:23], v[42:43], v[170:171], 0
    v_cvt_pk_bf16_f32 v164, v24, v25
    v_cvt_pk_bf16_f32 v165, v26, v27
    v_mfma_f32_4x4x4_16b_bf16 v[24:27], v[44:45], v[172:173], 0
    v_cvt_pk_bf16_f32 v166, v28, v29
    v_cvt_pk_bf16_f32 v167, v30, v31
    v_mfma_f32_4x4x4_16b_bf16 v[28:31], v[46:47], v[174:175], 0
    v_cvt_pk_bf16_f32 v168, v16, v17
    v_cvt_pk_bf16_f32 v169, v18, v19
    ds_read_b64_tr_b16 v[198:199], v8 offset:9216
    ds_read_b64_tr_b16 v[200:201], v8 offset:16384
    ds_read_b64_tr_b16 v[202:203], v8 offset:17408
    ds_read_b64_tr_b16 v[204:205], v8 offset:24576
    s_waitcnt lgkmcnt(11)
    v_mfma_f32_4x4x4_16b_bf16 v[16:19], v[32:33], v[176:177], 0
    v_cvt_pk_bf16_f32 v170, v20, v21
    v_cvt_pk_bf16_f32 v171, v22, v23
    v_mfma_f32_4x4x4_16b_bf16 v[20:23], v[34:35], v[178:179], 0
    v_cvt_pk_bf16_f32 v172, v24, v25
    v_cvt_pk_bf16_f32 v173, v26, v27
    v_mfma_f32_4x4x4_16b_bf16 v[24:27], v[36:37], v[180:181], 0
    v_cvt_pk_bf16_f32 v174, v28, v29
    v_cvt_pk_bf16_f32 v175, v30, v31
    v_mfma_f32_4x4x4_16b_bf16 v[28:31], v[38:39], v[182:183], 0
    v_cvt_pk_bf16_f32 v176, v16, v17
    v_cvt_pk_bf16_f32 v177, v18, v19
    ds_read_b64_tr_b16 v[206:207], v8 offset:25600
    ds_read_b64_tr_b16 v[208:209], v9 offset:0
    ds_read_b64_tr_b16 v[210:211], v9 offset:1024
    ds_read_b64_tr_b16 v[212:213], v9 offset:8192
    s_waitcnt lgkmcnt(11)
    v_mfma_f32_4x4x4_16b_bf16 v[16:19], v[40:41], v[184:185], 0
    v_cvt_pk_bf16_f32 v178, v20, v21
    v_cvt_pk_bf16_f32 v179, v22, v23
    v_mfma_f32_4x4x4_16b_bf16 v[20:23], v[42:43], v[186:187], 0
    v_cvt_pk_bf16_f32 v180, v24, v25
    v_cvt_pk_bf16_f32 v181, v26, v27
    v_mfma_f32_4x4x4_16b_bf16 v[24:27], v[44:45], v[188:189], 0
    v_cvt_pk_bf16_f32 v182, v28, v29
    v_cvt_pk_bf16_f32 v183, v30, v31
    v_mfma_f32_4x4x4_16b_bf16 v[28:31], v[46:47], v[190:191], 0
    v_cvt_pk_bf16_f32 v184, v16, v17
    v_cvt_pk_bf16_f32 v185, v18, v19
    ds_read_b64_tr_b16 v[214:215], v9 offset:9216
    ds_read_b64_tr_b16 v[216:217], v9 offset:16384
    ds_read_b64_tr_b16 v[218:219], v9 offset:17408
    ds_read_b64_tr_b16 v[220:221], v9 offset:24576
    s_waitcnt lgkmcnt(11)
    v_mfma_f32_4x4x4_16b_bf16 v[16:19], v[32:33], v[192:193], 0
    v_cvt_pk_bf16_f32 v186, v20, v21
    v_cvt_pk_bf16_f32 v187, v22, v23
    v_mfma_f32_4x4x4_16b_bf16 v[20:23], v[34:35], v[194:195], 0
    v_cvt_pk_bf16_f32 v188, v24, v25
    v_cvt_pk_bf16_f32 v189, v26, v27
    v_mfma_f32_4x4x4_16b_bf16 v[24:27], v[36:37], v[196:197], 0
    v_cvt_pk_bf16_f32 v190, v28, v29
    v_cvt_pk_bf16_f32 v191, v30, v31
    v_mfma_f32_4x4x4_16b_bf16 v[28:31], v[38:39], v[198:199], 0
    v_cvt_pk_bf16_f32 v192, v16, v17
    v_cvt_pk_bf16_f32 v193, v18, v19
    ds_read_b64_tr_b16 v[222:223], v9 offset:25600
    ds_read_b64_tr_b16 v[224:225], v10 offset:0
    ds_read_b64_tr_b16 v[226:227], v10 offset:1024
    ds_read_b64_tr_b16 v[228:229], v10 offset:8192
    s_waitcnt lgkmcnt(11)
    v_mfma_f32_4x4x4_16b_bf16 v[16:19], v[40:41], v[200:201], 0
    v_cvt_pk_bf16_f32 v194, v20, v21
    v_cvt_pk_bf16_f32 v195, v22, v23
    v_mfma_f32_4x4x4_16b_bf16 v[20:23], v[42:43], v[202:203], 0
    v_cvt_pk_bf16_f32 v196, v24, v25
    v_cvt_pk_bf16_f32 v197, v26, v27
    v_mfma_f32_4x4x4_16b_bf16 v[24:27], v[44:45], v[204:205], 0
    v_cvt_pk_bf16_f32 v198, v28, v29
    v_cvt_pk_bf16_f32 v199, v30, v31
    v_mfma_f32_4x4x4_16b_bf16 v[28:31], v[46:47], v[206:207], 0
    v_cvt_pk_bf16_f32 v200, v16, v17
    v_cvt_pk_bf16_f32 v201, v18, v19
    ds_read_b64_tr_b16 v[230:231], v10 offset:9216
    ds_read_b64_tr_b16 v[232:233], v10 offset:16384
    ds_read_b64_tr_b16 v[234:235], v10 offset:17408
    ds_read_b64_tr_b16 v[236:237], v10 offset:24576
    s_waitcnt lgkmcnt(11)
    v_mfma_f32_4x4x4_16b_bf16 v[16:19], v[32:33], v[208:209], 0
    v_cvt_pk_bf16_f32 v202, v20, v21
    v_cvt_pk_bf16_f32 v203, v22, v23
    v_mfma_f32_4x4x4_16b_bf16 v[20:23], v[34:35], v[210:211], 0
    v_cvt_pk_bf16_f32 v204, v24, v25
    v_cvt_pk_bf16_f32 v205, v26, v27
    v_mfma_f32_4x4x4_16b_bf16 v[24:27], v[36:37], v[212:213], 0
    v_cvt_pk_bf16_f32 v206, v28, v29
    v_cvt_pk_bf16_f32 v207, v30, v31
    v_mfma_f32_4x4x4_16b_bf16 v[28:31], v[38:39], v[214:215], 0
    v_cvt_pk_bf16_f32 v208, v16, v17
    v_cvt_pk_bf16_f32 v209, v18, v19
    ds_read_b64_tr_b16 v[238:239], v10 offset:25600
    ds_read_b64_tr_b16 v[240:241], v11 offset:0
    ds_read_b64_tr_b16 v[242:243], v11 offset:1024
    ds_read_b64_tr_b16 v[244:245], v11 offset:8192
    s_waitcnt lgkmcnt(11)
    v_mfma_f32_4x4x4_16b_bf16 v[16:19], v[40:41], v[216:217], 0
    v_cvt_pk_bf16_f32 v210, v20, v21
    v_cvt_pk_bf16_f32 v211, v22, v23
    v_mfma_f32_4x4x4_16b_bf16 v[20:23], v[42:43], v[218:219], 0
    v_cvt_pk_bf16_f32 v212, v24, v25
    v_cvt_pk_bf16_f32 v213, v26, v27
    v_mfma_f32_4x4x4_16b_bf16 v[24:27], v[44:45], v[220:221], 0
    v_cvt_pk_bf16_f32 v214, v28, v29
    v_cvt_pk_bf16_f32 v215, v30, v31
    v_mfma_f32_4x4x4_16b_bf16 v[28:31], v[46:47], v[222:223], 0
    v_cvt_pk_bf16_f32 v216, v16, v17
    v_cvt_pk_bf16_f32 v217, v18, v19
    ds_read_b64_tr_b16 v[246:247], v11 offset:9216
    ds_read_b64_tr_b16 v[248:249], v11 offset:16384
    ds_read_b64_tr_b16 v[250:251], v11 offset:17408
    ds_read_b64_tr_b16 v[252:253], v11 offset:24576
    s_waitcnt lgkmcnt(11)
    v_mfma_f32_4x4x4_16b_bf16 v[16:19], v[32:33], v[224:225], 0
    v_cvt_pk_bf16_f32 v218, v20, v21
    v_cvt_pk_bf16_f32 v219, v22, v23
    v_mfma_f32_4x4x4_16b_bf16 v[20:23], v[34:35], v[226:227], 0
    v_cvt_pk_bf16_f32 v220, v24, v25
    v_cvt_pk_bf16_f32 v221, v26, v27
    v_mfma_f32_4x4x4_16b_bf16 v[24:27], v[36:37], v[228:229], 0
    v_cvt_pk_bf16_f32 v222, v28, v29
    v_cvt_pk_bf16_f32 v223, v30, v31
    v_mfma_f32_4x4x4_16b_bf16 v[28:31], v[38:39], v[230:231], 0
    v_cvt_pk_bf16_f32 v224, v16, v17
    v_cvt_pk_bf16_f32 v225, v18, v19
    ds_read_b64_tr_b16 v[254:255], v11 offset:25600
    v_xor_b32 v4, v2, v3
    v_lshlrev_b32 v4, 4, v4
    v_lshl_add_u32 v4, v3, 8, v4
    v_xor_b32 v5, 64, v4
    v_xor_b32 v6, 128, v4
    v_xor_b32 v7, 192, v4
    s_lshl_b32 s46, s3, 11
    s_add_u32 s46, s46, 147456
    v_lshlrev_b32 v1, 2, v0
    v_add_u32 v1, s46, v1
    v_mov_b32 v3, 130816
    s_lshl_b32 s46, s3, 8
    s_add_u32 s46, s46, 161536
    v_lshlrev_b32 v0, 2, v0
    v_add_u32 v0, s46, v0
    v_mov_b32 v12, 130912
    ds_read_b128 v[12:15], v12
    v_lshlrev_b32 v48, 8, v2
    v_add_u32 v48, 122880, v48
    s_waitcnt lgkmcnt(9)
    v_mfma_f32_4x4x4_16b_bf16 v[16:19], v[40:41], v[232:233], 0
    v_cvt_pk_bf16_f32 v226, v20, v21
    v_cvt_pk_bf16_f32 v227, v22, v23
    v_mfma_f32_4x4x4_16b_bf16 v[20:23], v[42:43], v[234:235], 0
    v_cvt_pk_bf16_f32 v228, v24, v25
    v_cvt_pk_bf16_f32 v229, v26, v27
    v_mfma_f32_4x4x4_16b_bf16 v[24:27], v[44:45], v[236:237], 0
    v_cvt_pk_bf16_f32 v230, v28, v29
    v_cvt_pk_bf16_f32 v231, v30, v31
    v_mfma_f32_4x4x4_16b_bf16 v[28:31], v[46:47], v[238:239], 0
    v_cvt_pk_bf16_f32 v232, v16, v17
    v_cvt_pk_bf16_f32 v233, v18, v19
    s_waitcnt lgkmcnt(0)
    v_add3_u32 v12, v12, v13, v14
    v_add_u32 v12, v12, v15
    s_nop 0
    v_readfirstlane_b32 s46, v12
    s_cmp_eq_u32 s46, 4
    s_cbranch_scc1 afm_tab_kernel_hbok
    v_mov_b32 v49, 130912
afm_tab_kernel_pollH:
    ds_read_b128 v[12:15], v49 offset:0
    s_waitcnt lgkmcnt(0)
    v_add3_u32 v12, v12, v13, v14
    v_add_u32 v12, v12, v15
    s_nop 0
    v_readfirstlane_b32 s46, v12
    s_cmp_eq_u32 s46, 4
    s_cbranch_scc1 afm_tab_kernel_pollH_ok
    s_sleep 2
    s_branch afm_tab_kernel_pollH
afm_tab_kernel_pollH_ok:
afm_tab_kernel_hbok:
    ds_read_b128 v[96:99], v48 offset:0
    ds_read_b128 v[100:103], v48 offset:16
    ds_read_b128 v[104:107], v48 offset:32
    ds_read_b128 v[108:111], v48 offset:48
    ds_read_b128 v[112:115], v48 offset:64
    ds_read_b128 v[116:119], v48 offset:80
    ds_read_b128 v[120:123], v48 offset:96
    ds_read_b128 v[124:127], v48 offset:112
    v_mfma_f32_4x4x4_16b_bf16 v[16:19], v[32:33], v[240:241], 0
    v_cvt_pk_bf16_f32 v234, v20, v21
    v_cvt_pk_bf16_f32 v235, v22, v23
    v_mfma_f32_4x4x4_16b_bf16 v[20:23], v[34:35], v[242:243], 0
    v_cvt_pk_bf16_f32 v236, v24, v25
    v_cvt_pk_bf16_f32 v237, v26, v27
    v_mfma_f32_4x4x4_16b_bf16 v[24:27], v[36:37], v[244:245], 0
    v_cvt_pk_bf16_f32 v238, v28, v29
    v_cvt_pk_bf16_f32 v239, v30, v31
    v_mfma_f32_4x4x4_16b_bf16 v[28:31], v[38:39], v[246:247], 0
    v_cvt_pk_bf16_f32 v240, v16, v17
    v_cvt_pk_bf16_f32 v241, v18, v19
    s_waitcnt lgkmcnt(4)
    ds_read_b128 v[64:67], v48 offset:128
    ds_read_b128 v[68:71], v48 offset:144
    ds_read_b128 v[72:75], v48 offset:160
    ds_read_b128 v[76:79], v48 offset:176
    ds_read_b128 v[80:83], v48 offset:192
    ds_read_b128 v[84:87], v48 offset:208
    ds_read_b128 v[88:91], v48 offset:224
    ds_read_b128 v[92:95], v48 offset:240
    v_mfma_f32_4x4x4_16b_bf16 v[16:19], v[40:41], v[248:249], 0
    v_cvt_pk_bf16_f32 v242, v20, v21
    v_cvt_pk_bf16_f32 v243, v22, v23
    v_mfma_f32_4x4x4_16b_bf16 v[20:23], v[42:43], v[250:251], 0
    v_cvt_pk_bf16_f32 v244, v24, v25
    v_cvt_pk_bf16_f32 v245, v26, v27
    v_mfma_f32_4x4x4_16b_bf16 v[24:27], v[44:45], v[252:253], 0
    v_cvt_pk_bf16_f32 v246, v28, v29
    v_cvt_pk_bf16_f32 v247, v30, v31
    v_mfma_f32_4x4x4_16b_bf16 v[28:31], v[46:47], v[254:255], 0
    v_cvt_pk_bf16_f32 v248, v16, v17
    v_cvt_pk_bf16_f32 v249, v18, v19
    s_waitcnt lgkmcnt(0)
    s_barrier
    ds_read_b128 v[32:35], v4
    ds_read_b128 v[36:39], v5
    ds_read_b128 v[40:43], v6
    ds_read_b128 v[44:47], v7
    v_mov_b32 v12, 0
    ds_write_b32 v0, v12
    v_cvt_pk_bf16_f32 v250, v20, v21
    v_cvt_pk_bf16_f32 v251, v22, v23
    v_cvt_pk_bf16_f32 v252, v24, v25
    v_cvt_pk_bf16_f32 v253, v26, v27
    s_nop 0
    v_cvt_pk_bf16_f32 v254, v28, v29
    v_cvt_pk_bf16_f32 v255, v30, v31
    s_mov_b32 s47, 0
afm_tab_kernel_loop:
    s_waitcnt lgkmcnt(0)
    s_cmp_lg_u32 s47, 2
    s_cbranch_scc1 afm_tab_kernel_nopoll
    v_add3_u32 v12, v12, v13, v14
    v_add_u32 v12, v12, v15
    s_nop 0
    v_readfirstlane_b32 s46, v12
    s_cmp_eq_u32 s46, 4
    s_cbranch_scc1 afm_tab_kernel_pollok
afm_tab_kernel_poll:
    ds_read_b128 v[12:15], v3 offset:0
    s_waitcnt lgkmcnt(0)
    v_add3_u32 v12, v12, v13, v14
    v_add_u32 v12, v12, v15
    s_nop 0
    v_readfirstlane_b32 s46, v12
    s_cmp_eq_u32 s46, 4
    s_cbranch_scc1 afm_tab_kernel_poll_ok
    s_sleep 2
    s_branch afm_tab_kernel_poll
afm_tab_kernel_poll_ok:
afm_tab_kernel_pollok:
    v_mov_b32 v3, 130896
afm_tab_kernel_nopoll:
    v_mfma_f32_16x16x32_bf16 v[16:19], v[128:131], v[32:35], v[64:67]
    v_fma_f32 v11, |v24|, v120, v11
    v_mfma_f32_16x16x32_bf16 v[16:19], v[132:135], v[36:39], v[16:19]
    v_fma_f32 v11, |v25|, v121, v11
    v_mfma_f32_16x16x32_bf16 v[16:19], v[136:139], v[40:43], v[16:19]
    ds_read_b128 v[48:51], v4 offset:4096
    v_mfma_f32_16x16x32_bf16 v[16:19], v[140:143], v[44:47], v[16:19]
    v_fma_f32 v11, |v26|, v122, v11
    v_fma_f32 v11, |v27|, v123, v11
    v_mfma_f32_16x16x32_bf16 v[20:23], v[144:147], v[32:35], v[68:71]
    v_fma_f32 v11, |v28|, v124, v11
    v_mfma_f32_16x16x32_bf16 v[20:23], v[148:151], v[36:39], v[20:23]
    v_fma_f32 v11, |v29|, v125, v11
    v_mfma_f32_16x16x32_bf16 v[20:23], v[152:155], v[40:43], v[20:23]
    ds_read_b128 v[52:55], v5 offset:4096
    v_mfma_f32_16x16x32_bf16 v[20:23], v[156:159], v[44:47], v[20:23]
    v_fma_f32 v11, |v30|, v126, v11
    v_fma_f32 v11, |v31|, v127, v11
    v_mfma_f32_16x16x32_bf16 v[24:27], v[160:163], v[32:35], v[72:75]
    v_mul_f32 v8, |v16|, v96
    v_mfma_f32_16x16x32_bf16 v[24:27], v[164:167], v[36:39], v[24:27]
    v_fma_f32 v8, |v17|, v97, v8
    v_permlane16_swap_b32 v10, v11
    v_mfma_f32_16x16x32_bf16 v[24:27], v[168:171], v[40:43], v[24:27]
    ds_read_b128 v[56:59], v6 offset:4096
    v_mfma_f32_16x16x32_bf16 v[24:27], v[172:175], v[44:47], v[24:27]
    v_fma_f32 v8, |v18|, v98, v8
    v_fma_f32 v8, |v19|, v99, v8
    v_mfma_f32_16x16x32_bf16 v[28:31], v[176:179], v[32:35], v[76:79]
    v_fma_f32 v8, |v20|, v100, v8
    v_add_f32 v10, v10, v11
    v_mfma_f32_16x16x32_bf16 v[28:31], v[180:183], v[36:39], v[28:31]
    v_fma_f32 v8, |v21|, v101, v8
    v_permlane32_swap_b32 v2, v10
    v_mfma_f32_16x16x32_bf16 v[28:31], v[184:187], v[40:43], v[28:31]
    ds_read_b128 v[60:63], v7 offset:4096
    v_mfma_f32_16x16x32_bf16 v[28:31], v[188:191], v[44:47], v[28:31]
    v_fma_f32 v8, |v22|, v102, v8
    v_fma_f32 v8, |v23|, v103, v8
    v_mfma_f32_16x16x32_bf16 v[16:19], v[192:195], v[32:35], v[80:83]
    v_fma_f32 v8, |v24|, v104, v8
    v_add_f32 v2, v2, v10
    v_mfma_f32_16x16x32_bf16 v[16:19], v[196:199], v[36:39], v[16:19]
    v_fma_f32 v8, |v25|, v105, v8
    ds_write_b32 v1, v2
    v_mfma_f32_16x16x32_bf16 v[16:19], v[200:203], v[40:43], v[16:19]
    v_fma_f32 v8, |v26|, v106, v8
    v_add_u32 v1, 256, v1
    v_mfma_f32_16x16x32_bf16 v[16:19], v[204:207], v[44:47], v[16:19]
    v_fma_f32 v8, |v27|, v107, v8
    v_mfma_f32_16x16x32_bf16 v[20:23], v[208:211], v[32:35], v[84:87]
    v_fma_f32 v8, |v28|, v108, v8
    ds_write_b32 v0, v1
    v_mfma_f32_16x16x32_bf16 v[20:23], v[212:215], v[36:39], v[20:23]
    v_fma_f32 v8, |v29|, v109, v8
    v_mfma_f32_16x16x32_bf16 v[20:23], v[216:219], v[40:43], v[20:23]
    v_fma_f32 v8, |v30|, v110, v8
    v_mfma_f32_16x16x32_bf16 v[20:23], v[220:223], v[44:47], v[20:23]
    v_fma_f32 v8, |v31|, v111, v8
    v_mfma_f32_16x16x32_bf16 v[24:27], v[224:227], v[32:35], v[88:91]
    v_fma_f32 v8, |v16|, v112, v8
    v_mfma_f32_16x16x32_bf16 v[24:27], v[228:231], v[36:39], v[24:27]
    v_fma_f32 v8, |v17|, v113, v8
    v_mfma_f32_16x16x32_bf16 v[24:27], v[232:235], v[40:43], v[24:27]
    v_fma_f32 v8, |v18|, v114, v8
    v_mfma_f32_16x16x32_bf16 v[24:27], v[236:239], v[44:47], v[24:27]
    v_fma_f32 v8, |v19|, v115, v8
    v_mfma_f32_16x16x32_bf16 v[28:31], v[240:243], v[32:35], v[92:95]
    v_fma_f32 v8, |v20|, v116, v8
    v_mfma_f32_16x16x32_bf16 v[28:31], v[244:247], v[36:39], v[28:31]
    v_fma_f32 v8, |v21|, v117, v8
    v_mfma_f32_16x16x32_bf16 v[28:31], v[248:251], v[40:43], v[28:31]
    v_fma_f32 v8, |v22|, v118, v8
    v_mfma_f32_16x16x32_bf16 v[28:31], v[252:255], v[44:47], v[28:31]
    v_fma_f32 v8, |v23|, v119, v8
    s_waitcnt lgkmcnt(0)
    v_mfma_f32_16x16x32_bf16 v[16:19], v[128:131], v[48:51], v[64:67]
    v_fma_f32 v8, |v24|, v120, v8
    v_mfma_f32_16x16x32_bf16 v[16:19], v[132:135], v[52:55], v[16:19]
    v_fma_f32 v8, |v25|, v121, v8
    v_mfma_f32_16x16x32_bf16 v[16:19], v[136:139], v[56:59], v[16:19]
    ds_read_b128 v[32:35], v4 offset:8192
    v_mfma_f32_16x16x32_bf16 v[16:19], v[140:143], v[60:63], v[16:19]
    v_fma_f32 v8, |v26|, v122, v8
    v_fma_f32 v8, |v27|, v123, v8
    v_mfma_f32_16x16x32_bf16 v[20:23], v[144:147], v[48:51], v[68:71]
    v_fma_f32 v8, |v28|, v124, v8
    v_mfma_f32_16x16x32_bf16 v[20:23], v[148:151], v[52:55], v[20:23]
    v_fma_f32 v8, |v29|, v125, v8
    v_mfma_f32_16x16x32_bf16 v[20:23], v[152:155], v[56:59], v[20:23]
    ds_read_b128 v[36:39], v5 offset:8192
    v_mfma_f32_16x16x32_bf16 v[20:23], v[156:159], v[60:63], v[20:23]
    v_fma_f32 v8, |v30|, v126, v8
    v_fma_f32 v8, |v31|, v127, v8
    v_mfma_f32_16x16x32_bf16 v[24:27], v[160:163], v[48:51], v[72:75]
    v_mul_f32 v9, |v16|, v96
    v_mfma_f32_16x16x32_bf16 v[24:27], v[164:167], v[52:55], v[24:27]
    v_fma_f32 v9, |v17|, v97, v9
    v_mfma_f32_16x16x32_bf16 v[24:27], v[168:171], v[56:59], v[24:27]
    ds_read_b128 v[40:43], v6 offset:8192
    v_mfma_f32_16x16x32_bf16 v[24:27], v[172:175], v[60:63], v[24:27]
    v_fma_f32 v9, |v18|, v98, v9
    v_fma_f32 v9, |v19|, v99, v9
    v_mfma_f32_16x16x32_bf16 v[28:31], v[176:179], v[48:51], v[76:79]
    v_fma_f32 v9, |v20|, v100, v9
    v_mfma_f32_16x16x32_bf16 v[28:31], v[180:183], v[52:55], v[28:31]
    v_fma_f32 v9, |v21|, v101, v9
    v_mfma_f32_16x16x32_bf16 v[28:31], v[184:187], v[56:59], v[28:31]
    ds_read_b128 v[44:47], v7 offset:8192
    v_mfma_f32_16x16x32_bf16 v[28:31], v[188:191], v[60:63], v[28:31]
    v_fma_f32 v9, |v22|, v102, v9
    v_fma_f32 v9, |v23|, v103, v9
    v_mfma_f32_16x16x32_bf16 v[16:19], v[192:195], v[48:51], v[80:83]
    v_fma_f32 v9, |v24|, v104, v9
    v_mfma_f32_16x16x32_bf16 v[16:19], v[196:199], v[52:55], v[16:19]
    v_fma_f32 v9, |v25|, v105, v9
    v_mfma_f32_16x16x32_bf16 v[16:19], v[200:203], v[56:59], v[16:19]
    v_fma_f32 v9, |v26|, v106, v9
    v_mfma_f32_16x16x32_bf16 v[16:19], v[204:207], v[60:63], v[16:19]
    v_fma_f32 v9, |v27|, v107, v9
    v_mfma_f32_16x16x32_bf16 v[20:23], v[208:211], v[48:51], v[84:87]
    v_fma_f32 v9, |v28|, v108, v9
    v_mfma_f32_16x16x32_bf16 v[20:23], v[212:215], v[52:55], v[20:23]
    v_fma_f32 v9, |v29|, v109, v9
    v_mfma_f32_16x16x32_bf16 v[20:23], v[216:219], v[56:59], v[20:23]
    v_fma_f32 v9, |v30|, v110, v9
    v_mfma_f32_16x16x32_bf16 v[20:23], v[220:223], v[60:63], v[20:23]
    v_fma_f32 v9, |v31|, v111, v9
    v_mfma_f32_16x16x32_bf16 v[24:27], v[224:227], v[48:51], v[88:91]
    v_fma_f32 v9, |v16|, v112, v9
    v_mfma_f32_16x16x32_bf16 v[24:27], v[228:231], v[52:55], v[24:27]
    v_fma_f32 v9, |v17|, v113, v9
    v_mfma_f32_16x16x32_bf16 v[24:27], v[232:235], v[56:59], v[24:27]
    v_fma_f32 v9, |v18|, v114, v9
    v_mfma_f32_16x16x32_bf16 v[24:27], v[236:239], v[60:63], v[24:27]
    v_fma_f32 v9, |v19|, v115, v9
    v_mfma_f32_16x16x32_bf16 v[28:31], v[240:243], v[48:51], v[92:95]
    v_fma_f32 v9, |v20|, v116, v9
    v_mfma_f32_16x16x32_bf16 v[28:31], v[244:247], v[52:55], v[28:31]
    v_fma_f32 v9, |v21|, v117, v9
    v_mfma_f32_16x16x32_bf16 v[28:31], v[248:251], v[56:59], v[28:31]
    v_fma_f32 v9, |v22|, v118, v9
    v_mfma_f32_16x16x32_bf16 v[28:31], v[252:255], v[60:63], v[28:31]
    v_fma_f32 v9, |v23|, v119, v9
    s_waitcnt lgkmcnt(0)
    v_mfma_f32_16x16x32_bf16 v[16:19], v[128:131], v[32:35], v[64:67]
    v_fma_f32 v9, |v24|, v120, v9
    v_mfma_f32_16x16x32_bf16 v[16:19], v[132:135], v[36:39], v[16:19]
    v_fma_f32 v9, |v25|, v121, v9
    v_mfma_f32_16x16x32_bf16 v[16:19], v[136:139], v[40:43], v[16:19]
    ds_read_b128 v[48:51], v4 offset:12288
    v_mfma_f32_16x16x32_bf16 v[16:19], v[140:143], v[44:47], v[16:19]
    v_fma_f32 v9, |v26|, v122, v9
    v_fma_f32 v9, |v27|, v123, v9
    v_mfma_f32_16x16x32_bf16 v[20:23], v[144:147], v[32:35], v[68:71]
    v_fma_f32 v9, |v28|, v124, v9
    v_mfma_f32_16x16x32_bf16 v[20:23], v[148:151], v[36:39], v[20:23]
    v_fma_f32 v9, |v29|, v125, v9
    v_mfma_f32_16x16x32_bf16 v[20:23], v[152:155], v[40:43], v[20:23]
    ds_read_b128 v[52:55], v5 offset:12288
    v_mfma_f32_16x16x32_bf16 v[20:23], v[156:159], v[44:47], v[20:23]
    v_fma_f32 v9, |v30|, v126, v9
    v_fma_f32 v9, |v31|, v127, v9
    v_mfma_f32_16x16x32_bf16 v[24:27], v[160:163], v[32:35], v[72:75]
    v_mul_f32 v10, |v16|, v96
    v_mfma_f32_16x16x32_bf16 v[24:27], v[164:167], v[36:39], v[24:27]
    v_fma_f32 v10, |v17|, v97, v10
    v_permlane16_swap_b32 v8, v9
    v_mfma_f32_16x16x32_bf16 v[24:27], v[168:171], v[40:43], v[24:27]
    ds_read_b128 v[56:59], v6 offset:12288
    v_mfma_f32_16x16x32_bf16 v[24:27], v[172:175], v[44:47], v[24:27]
    v_fma_f32 v10, |v18|, v98, v10
    v_fma_f32 v10, |v19|, v99, v10
    v_mfma_f32_16x16x32_bf16 v[28:31], v[176:179], v[32:35], v[76:79]
    v_fma_f32 v10, |v20|, v100, v10
    v_add_f32 v2, v8, v9
    v_mfma_f32_16x16x32_bf16 v[28:31], v[180:183], v[36:39], v[28:31]
    v_fma_f32 v10, |v21|, v101, v10
    v_mfma_f32_16x16x32_bf16 v[28:31], v[184:187], v[40:43], v[28:31]
    ds_read_b128 v[60:63], v7 offset:12288
    v_mfma_f32_16x16x32_bf16 v[28:31], v[188:191], v[44:47], v[28:31]
    v_fma_f32 v10, |v22|, v102, v10
    v_fma_f32 v10, |v23|, v103, v10
    v_mfma_f32_16x16x32_bf16 v[16:19], v[192:195], v[32:35], v[80:83]
    v_fma_f32 v10, |v24|, v104, v10
    v_mfma_f32_16x16x32_bf16 v[16:19], v[196:199], v[36:39], v[16:19]
    v_fma_f32 v10, |v25|, v105, v10
    v_mfma_f32_16x16x32_bf16 v[16:19], v[200:203], v[40:43], v[16:19]
    v_fma_f32 v10, |v26|, v106, v10
    v_mfma_f32_16x16x32_bf16 v[16:19], v[204:207], v[44:47], v[16:19]
    v_fma_f32 v10, |v27|, v107, v10
    v_mfma_f32_16x16x32_bf16 v[20:23], v[208:211], v[32:35], v[84:87]
    v_fma_f32 v10, |v28|, v108, v10
    v_mfma_f32_16x16x32_bf16 v[20:23], v[212:215], v[36:39], v[20:23]
    v_fma_f32 v10, |v29|, v109, v10
    v_mfma_f32_16x16x32_bf16 v[20:23], v[216:219], v[40:43], v[20:23]
    v_fma_f32 v10, |v30|, v110, v10
    v_mfma_f32_16x16x32_bf16 v[20:23], v[220:223], v[44:47], v[20:23]
    v_fma_f32 v10, |v31|, v111, v10
    v_mfma_f32_16x16x32_bf16 v[24:27], v[224:227], v[32:35], v[88:91]
    v_fma_f32 v10, |v16|, v112, v10
    v_mfma_f32_16x16x32_bf16 v[24:27], v[228:231], v[36:39], v[24:27]
    v_fma_f32 v10, |v17|, v113, v10
    v_mfma_f32_16x16x32_bf16 v[24:27], v[232:235], v[40:43], v[24:27]
    v_fma_f32 v10, |v18|, v114, v10
    v_mfma_f32_16x16x32_bf16 v[24:27], v[236:239], v[44:47], v[24:27]
    v_fma_f32 v10, |v19|, v115, v10
    v_mfma_f32_16x16x32_bf16 v[28:31], v[240:243], v[32:35], v[92:95]
    v_fma_f32 v10, |v20|, v116, v10
    v_mfma_f32_16x16x32_bf16 v[28:31], v[244:247], v[36:39], v[28:31]
    v_fma_f32 v10, |v21|, v117, v10
    v_mfma_f32_16x16x32_bf16 v[28:31], v[248:251], v[40:43], v[28:31]
    v_fma_f32 v10, |v22|, v118, v10
    v_mfma_f32_16x16x32_bf16 v[28:31], v[252:255], v[44:47], v[28:31]
    v_fma_f32 v10, |v23|, v119, v10
    s_cmp_eq_u32 s47, s85
    s_cbranch_scc1 afm_tab_kernel_stail
    s_waitcnt lgkmcnt(0)
    v_mfma_f32_16x16x32_bf16 v[16:19], v[128:131], v[48:51], v[64:67]
    v_fma_f32 v10, |v24|, v120, v10
    v_mfma_f32_16x16x32_bf16 v[16:19], v[132:135], v[52:55], v[16:19]
    v_fma_f32 v10, |v25|, v121, v10
    v_mfma_f32_16x16x32_bf16 v[16:19], v[136:139], v[56:59], v[16:19]
    ds_read_b128 v[32:35], v4 offset:16384
    v_mfma_f32_16x16x32_bf16 v[16:19], v[140:143], v[60:63], v[16:19]
    v_fma_f32 v10, |v26|, v122, v10
    v_fma_f32 v10, |v27|, v123, v10
    v_mfma_f32_16x16x32_bf16 v[20:23], v[144:147], v[48:51], v[68:71]
    ds_read_b128 v[12:15], v3
    v_mfma_f32_16x16x32_bf16 v[20:23], v[148:151], v[52:55], v[20:23]
    v_fma_f32 v10, |v28|, v124, v10
    v_fma_f32 v10, |v29|, v125, v10
    v_mfma_f32_16x16x32_bf16 v[20:23], v[152:155], v[56:59], v[20:23]
    ds_read_b128 v[36:39], v5 offset:16384
    v_mfma_f32_16x16x32_bf16 v[20:23], v[156:159], v[60:63], v[20:23]
    v_fma_f32 v10, |v30|, v126, v10
    v_fma_f32 v10, |v31|, v127, v10
    v_mfma_f32_16x16x32_bf16 v[24:27], v[160:163], v[48:51], v[72:75]
    v_mul_f32 v11, |v16|, v96
    v_mfma_f32_16x16x32_bf16 v[24:27], v[164:167], v[52:55], v[24:27]
    v_fma_f32 v11, |v17|, v97, v11
    v_mfma_f32_16x16x32_bf16 v[24:27], v[168:171], v[56:59], v[24:27]
    ds_read_b128 v[40:43], v6 offset:16384
    v_mfma_f32_16x16x32_bf16 v[24:27], v[172:175], v[60:63], v[24:27]
    v_fma_f32 v11, |v18|, v98, v11
    v_fma_f32 v11, |v19|, v99, v11
    v_mfma_f32_16x16x32_bf16 v[28:31], v[176:179], v[48:51], v[76:79]
    v_fma_f32 v11, |v20|, v100, v11
    v_mfma_f32_16x16x32_bf16 v[28:31], v[180:183], v[52:55], v[28:31]
    v_fma_f32 v11, |v21|, v101, v11
    v_mfma_f32_16x16x32_bf16 v[28:31], v[184:187], v[56:59], v[28:31]
    ds_read_b128 v[44:47], v7 offset:16384
    v_mfma_f32_16x16x32_bf16 v[28:31], v[188:191], v[60:63], v[28:31]
    v_fma_f32 v11, |v22|, v102, v11
    v_fma_f32 v11, |v23|, v103, v11
    v_mfma_f32_16x16x32_bf16 v[16:19], v[192:195], v[48:51], v[80:83]
    v_fma_f32 v11, |v24|, v104, v11
    v_add_u32 v4, 16384, v4
    v_mfma_f32_16x16x32_bf16 v[16:19], v[196:199], v[52:55], v[16:19]
    v_fma_f32 v11, |v25|, v105, v11
    v_add_u32 v5, 16384, v5
    v_mfma_f32_16x16x32_bf16 v[16:19], v[200:203], v[56:59], v[16:19]
    v_fma_f32 v11, |v26|, v106, v11
    v_add_u32 v6, 16384, v6
    v_mfma_f32_16x16x32_bf16 v[16:19], v[204:207], v[60:63], v[16:19]
    v_fma_f32 v11, |v27|, v107, v11
    v_add_u32 v7, 16384, v7
    v_mfma_f32_16x16x32_bf16 v[20:23], v[208:211], v[48:51], v[84:87]
    v_fma_f32 v11, |v28|, v108, v11
    v_mfma_f32_16x16x32_bf16 v[20:23], v[212:215], v[52:55], v[20:23]
    v_fma_f32 v11, |v29|, v109, v11
    v_mfma_f32_16x16x32_bf16 v[20:23], v[216:219], v[56:59], v[20:23]
    v_fma_f32 v11, |v30|, v110, v11
    v_mfma_f32_16x16x32_bf16 v[20:23], v[220:223], v[60:63], v[20:23]
    v_fma_f32 v11, |v31|, v111, v11
    v_mfma_f32_16x16x32_bf16 v[24:27], v[224:227], v[48:51], v[88:91]
    v_fma_f32 v11, |v16|, v112, v11
    v_mfma_f32_16x16x32_bf16 v[24:27], v[228:231], v[52:55], v[24:27]
    v_fma_f32 v11, |v17|, v113, v11
    v_mfma_f32_16x16x32_bf16 v[24:27], v[232:235], v[56:59], v[24:27]
    v_fma_f32 v11, |v18|, v114, v11
    v_mfma_f32_16x16x32_bf16 v[24:27], v[236:239], v[60:63], v[24:27]
    v_fma_f32 v11, |v19|, v115, v11
    v_mfma_f32_16x16x32_bf16 v[28:31], v[240:243], v[48:51], v[92:95]
    v_fma_f32 v11, |v20|, v116, v11
    v_mfma_f32_16x16x32_bf16 v[28:31], v[244:247], v[52:55], v[28:31]
    v_fma_f32 v11, |v21|, v117, v11
    v_mfma_f32_16x16x32_bf16 v[28:31], v[248:251], v[56:59], v[28:31]
    v_fma_f32 v11, |v22|, v118, v11
    v_mfma_f32_16x16x32_bf16 v[28:31], v[252:255], v[60:63], v[28:31]
    v_fma_f32 v11, |v23|, v119, v11
    s_add_u32 s47, s47, 1
    s_cmp_lt_u32 s47, 8
    s_cbranch_scc1 afm_tab_kernel_loop
    v_add3_u32 v12, v12, v13, v14
    v_add_u32 v12, v12, v15
    s_nop 0
    v_readfirstlane_b32 s46, v12
    s_cmp_eq_u32 s46, 4
    s_cbranch_scc1 afm_tab_kernel_lsokl
afm_tab_kernel_pollLl:
    ds_read_b128 v[12:15], v3 offset:0
    s_waitcnt lgkmcnt(0)
    v_add3_u32 v12, v12, v13, v14
    v_add_u32 v12, v12, v15
    s_nop 0
    v_readfirstlane_b32 s46, v12
    s_cmp_eq_u32 s46, 4
    s_cbranch_scc1 afm_tab_kernel_pollLl_ok
    s_sleep 2
    s_branch afm_tab_kernel_pollLl
afm_tab_kernel_pollLl_ok:
afm_tab_kernel_lsokl:
    s_mul_i32 s46, s3, 3584
    s_add_u32 s46, s46, -188416
    v_lshl_add_u32 v4, v0, 1, s46
    ds_read_b64 v[6:7], v4
    v_mbcnt_lo_u32_b32 v5, -1, 0
    v_mbcnt_hi_u32_b32 v5, -1, v5
    s_cmp_lt_u32 s40, 500
    s_cselect_b32 s46, 1, 0
    s_add_u32 s46, s46, s3
    s_add_u32 s46, s46, 51
    v_cmp_ge_u32 s[64:65], s46, v5
    s_sub_u32 s47, 552, s40
    v_subrev_u32 v13, s47, v5
    s_movk_i32 s47, 496
    v_cmp_gt_u32 s[66:67], s47, v13
    s_or_b64 s[64:65], s[64:65], s[66:67]
    v_cmp_gt_u32 s[66:67], 60, v5
    s_and_b64 s[64:65], s[64:65], s[66:67]
    v_cmp_gt_u32 s[66:67], 48, v5
    s_or_b64 s[64:65], s[64:65], s[66:67]
    s_not_b64 s[64:65], s[64:65]
    v_mov_b32 v12, 0xff800000
    s_mov_b32 s46, 0x3f38aa3b
    v_fma_f32 v11, |v24|, v120, v11
    v_fma_f32 v11, |v25|, v121, v11
    v_fma_f32 v11, |v26|, v122, v11
    v_fma_f32 v11, |v27|, v123, v11
    v_fma_f32 v11, |v28|, v124, v11
    v_fma_f32 v11, |v29|, v125, v11
    v_fma_f32 v11, |v30|, v126, v11
    v_fma_f32 v11, |v31|, v127, v11
    s_nop 1
    v_permlane16_swap_b32 v10, v11
    v_add_f32 v10, v10, v11
    s_nop 1
    v_permlane32_swap_b32 v2, v10
    v_add_f32 v2, v2, v10
    s_waitcnt lgkmcnt(0)
    v_fma_f32 v2, v2, s46, v6
    v_cvt_pk_bf16_f32 v2, v7, v2
    v_cndmask_b32 v2, v2, v12, s[64:65]
    ds_write_b32 v1, v2
    v_mov_b32 v0, v5
    s_branch afm_tab_kernel_tdone
afm_tab_kernel_stail:
    ds_read_b128 v[12:15], v3
    s_waitcnt lgkmcnt(0)
    v_add3_u32 v12, v12, v13, v14
    v_add_u32 v12, v12, v15
    s_nop 0
    v_readfirstlane_b32 s46, v12
    s_cmp_eq_u32 s46, 4
    s_cbranch_scc1 afm_tab_kernel_lsoks
afm_tab_kernel_pollLs:
    ds_read_b128 v[12:15], v3 offset:0
    s_waitcnt lgkmcnt(0)
    v_add3_u32 v12, v12, v13, v14
    v_add_u32 v12, v12, v15
    s_nop 0
    v_readfirstlane_b32 s46, v12
    s_cmp_eq_u32 s46, 4
    s_cbranch_scc1 afm_tab_kernel_pollLs_ok
    s_sleep 2
    s_branch afm_tab_kernel_pollLs
afm_tab_kernel_pollLs_ok:
afm_tab_kernel_lsoks:
    s_mul_i32 s46, s3, 3584
    s_add_u32 s46, s46, -188416
    v_lshl_add_u32 v4, v0, 1, s46
    ds_read_b64 v[6:7], v4
    v_mbcnt_lo_u32_b32 v5, -1, 0
    v_mbcnt_hi_u32_b32 v5, -1, v5
    v_cmp_le_u32 s[64:65], 48, v5
    v_mov_b32 v11, 0
    v_mov_b32 v12, 0xff800000
    s_mov_b32 s46, 0x3f38aa3b
    v_fma_f32 v10, |v24|, v120, v10
    v_fma_f32 v10, |v25|, v121, v10
    v_fma_f32 v10, |v26|, v122, v10
    v_fma_f32 v10, |v27|, v123, v10
    v_fma_f32 v10, |v28|, v124, v10
    v_fma_f32 v10, |v29|, v125, v10
    v_fma_f32 v10, |v30|, v126, v10
    v_fma_f32 v10, |v31|, v127, v10
    s_nop 1
    v_permlane16_swap_b32 v10, v11
    v_add_f32 v10, v10, v11
    s_nop 1
    v_permlane32_swap_b32 v2, v10
    v_add_f32 v2, v2, v10
    s_waitcnt lgkmcnt(0)
    v_fma_f32 v2, v2, s46, v6
    v_cvt_pk_bf16_f32 v2, v7, v2
    v_cndmask_b32 v2, v2, v12, s[64:65]
    ds_write_b32 v1, v2
    v_mov_b32 v0, v5
afm_tab_kernel_tdone:
    s_branch afm_tab_kernel_fin
afm_tab_kernel_helper:
    s_sub_u32 s50, s3, 4
    s_mov_b32 s16, s4
    s_mov_b32 s17, s5
    s_mov_b32 s18, 256000
    s_mov_b32 s19, 0x00020000
    s_lshl_b32 s42, s50, 2
    v_lshrrev_b32 v9, 2, v3
    v_lshlrev_b32 v9, 8, v9
    v_lshl_add_u32 v9, v2, 4, v9
    s_lshl_b32 s46, s40, 8
    s_lshl_b32 s47, s50, 6
    s_add_u32 s46, s46, s47
    buffer_load_dwordx4 v[52:55], v9, s[16:19], s46 offen
    v_add_u32 v6, s42, v2
    v_xor_b32 v7, v3, v6
    v_lshlrev_b32 v7, 4, v7
    v_lshl_add_u32 v120, v2, 8, v7
    s_add_u32 s48, s40, s42
    s_lshl_b32 s44, s50, 10
    s_cmp_ge_u32 s48, 1000
    s_cselect_b32 s46, 1000, 0
    s_sub_u32 s48, s48, s46
    s_add_u32 m0, s44, 0
    s_lshl_b32 s46, s48, 8
    buffer_load_dwordx4 v120, s[16:19], s46 offen lds
    s_add_u32 s48, s48, 16
    s_cmp_ge_u32 s48, 1000
    s_cselect_b32 s46, 1000, 0
    s_sub_u32 s48, s48, s46
    s_add_u32 m0, s44, 4096
    s_lshl_b32 s46, s48, 8
    buffer_load_dwordx4 v120, s[16:19], s46 offen lds
    s_add_u32 s48, s48, 16
    s_cmp_ge_u32 s48, 1000
    s_cselect_b32 s46, 1000, 0
    s_sub_u32 s48, s48, s46
    s_add_u32 m0, s44, 8192
    s_lshl_b32 s46, s48, 8
    buffer_load_dwordx4 v120, s[16:19], s46 offen lds
    s_add_u32 s48, s48, 16
    s_cmp_ge_u32 s48, 1000
    s_cselect_b32 s46, 1000, 0
    s_sub_u32 s48, s48, s46
    s_add_u32 m0, s44, 12288
    s_lshl_b32 s46, s48, 8
    buffer_load_dwordx4 v120, s[16:19], s46 offen lds
    v_and_b32 v8, 31, v0
    v_lshrrev_b32 v9, 2, v8
    v_and_b32 v8, 3, v8
    v_lshl_add_u32 v8, v9, 4, v8
    v_add_u32 v8, s42, v8
    v_lshrrev_b32 v9, 5, v0
    v_lshlrev_b32 v9, 8, v9
    v_lshl_add_u32 v8, v8, 1, v9
    v_add_u32 v24, 130048, v8
    s_lshl_b32 s46, s50, 8
    s_add_u32 s46, s46, 122880
    v_lshlrev_b32 v25, 2, v0
    v_add_u32 v25, s46, v25
    s_add_u32 s46, s42, 130912
    v_mov_b32 v26, s46
    v_mov_b32 v11, 1
    s_add_u32 s46, s42, 130832
    v_mov_b32 v10, s46
    v_lshrrev_b32 v8, 2, v3
    v_and_b32 v9, 3, v3
    v_lshl_add_u32 v8, v8, 3, v9
    v_and_b32 v9, 7, v3
    v_lshlrev_b32 v9, 1, v9
    v_xor_b32 v9, v9, v2
    v_lshlrev_b32 v9, 4, v9
    v_lshl_add_u32 v8, v8, 8, v9
    s_lshl_b32 s46, s50, 13
    s_add_u32 s46, s46, 131072
    v_add_u32 v4, s46, v8
    v_xor_b32 v5, 64, v4
    v_xor_b32 v6, 128, v4
    v_xor_b32 v7, 192, v4
    v_lshlrev_b32 v27, 4, v2
    v_add_u32 v27, 130048, v27
    s_lshl_b32 s46, s50, 6
    v_add_u32 v28, s46, v27
    v_lshlrev_b32 v15, 2, v0
    v_add_u32 v15, 130048, v15
    v_and_b32 v8, 3, v3
    v_mov_b32 v9, 0x3f38aa3b
    v_mov_b32 v16, 0
    v_cmp_eq_u32 vcc, 0, v8
    v_mov_b32 v17, -1
    v_lshlrev_b32 v29, 4, v0
    v_cndmask_b32 v13, v16, v9, vcc
    v_cmp_eq_u32 vcc, 1, v8
    v_add_u32 v29, 118784, v29
    v_add_u32 v30, s44, v29
    v_cndmask_b32 v14, v16, v17, vcc
    v_mov_b32 v12, 130816
    s_waitcnt vmcnt(5)
    s_barrier
    ds_read_u16 v9, v24
    ds_read_b128 v[160:163], v4 offset:0
    ds_read_b128 v[164:167], v5 offset:0
    ds_read_b128 v[168:171], v6 offset:0
    ds_read_b128 v[172:175], v7 offset:0
    ds_read_b128 v[176:179], v4 offset:1024
    ds_read_b128 v[180:183], v5 offset:1024
    ds_read_b128 v[184:187], v6 offset:1024
    ds_read_b128 v[188:191], v7 offset:1024
    ds_read_b128 v[32:35], v27 offset:0
    ds_read_b128 v[36:39], v27 offset:64
    ds_read_b128 v[40:43], v27 offset:128
    ds_read_b128 v[44:47], v27 offset:192
    ds_read_b128 v[48:51], v28 offset:512
    s_add_u32 s48, s48, 16
    s_cmp_ge_u32 s48, 1000
    s_cselect_b32 s46, 1000, 0
    s_sub_u32 s48, s48, s46
    s_add_u32 m0, s44, 16384
    s_lshl_b32 s46, s48, 8
    buffer_load_dwordx4 v120, s[16:19], s46 offen lds
    s_add_u32 s48, s48, 16
    s_cmp_ge_u32 s48, 1000
    s_cselect_b32 s46, 1000, 0
    s_sub_u32 s48, s48, s46
    s_add_u32 m0, s44, 20480
    s_lshl_b32 s46, s48, 8
    buffer_load_dwordx4 v120, s[16:19], s46 offen lds
    s_add_u32 s48, s48, 16
    s_cmp_ge_u32 s48, 1000
    s_cselect_b32 s46, 1000, 0
    s_sub_u32 s48, s48, s46
    s_add_u32 m0, s44, 24576
    s_lshl_b32 s46, s48, 8
    buffer_load_dwordx4 v120, s[16:19], s46 offen lds
    s_add_u32 s48, s48, 16
    s_cmp_ge_u32 s48, 1000
    s_cselect_b32 s46, 1000, 0
    s_sub_u32 s48, s48, s46
    s_add_u32 m0, s44, 28672
    s_lshl_b32 s46, s48, 8
    buffer_load_dwordx4 v120, s[16:19], s46 offen lds
    s_add_u32 s48, s48, 16
    s_cmp_ge_u32 s48, 1000
    s_cselect_b32 s46, 1000, 0
    s_sub_u32 s48, s48, s46
    s_add_u32 m0, s44, 32768
    s_lshl_b32 s46, s48, 8
    buffer_load_dwordx4 v120, s[16:19], s46 offen lds
    s_waitcnt lgkmcnt(13)
    v_lshlrev_b32 v9, 16, v9
    ds_write_b32 v25, v9
    s_waitcnt lgkmcnt(0)
    ds_write_b32 v26, v11
    v_mfma_f32_16x16x32_bf16 v[128:131], v[160:163], v[32:35], 0
    v_mfma_f32_16x16x32_bf16 v[128:131], v[164:167], v[36:39], v[128:131]
    v_mfma_f32_16x16x32_bf16 v[128:131], v[168:171], v[40:43], v[128:131]
    v_mfma_f32_16x16x32_bf16 v[128:131], v[172:175], v[44:47], v[128:131]
    v_mfma_f32_16x16x32_bf16 v[132:135], v[176:179], v[32:35], 0
    v_mfma_f32_16x16x32_bf16 v[132:135], v[180:183], v[36:39], v[132:135]
    v_mfma_f32_16x16x32_bf16 v[132:135], v[184:187], v[40:43], v[132:135]
    v_mfma_f32_16x16x32_bf16 v[132:135], v[188:191], v[44:47], v[132:135]
    ds_read_b32 v64, v15
    ds_read_b32 v65, v15 offset:256
    v_and_b32 v48, v48, v14
    v_and_b32 v49, v49, v14
    v_and_b32 v50, v50, v14
    v_and_b32 v51, v51, v14
    s_waitcnt vmcnt(9)
    v_lshlrev_b32 v56, 16, v48
    v_and_b32 v57, 0xffff0000, v48
    v_lshlrev_b32 v136, 16, v52
    v_and_b32 v137, 0xffff0000, v52
    v_lshlrev_b32 v58, 16, v49
    v_and_b32 v59, 0xffff0000, v49
    v_lshlrev_b32 v138, 16, v53
    v_and_b32 v139, 0xffff0000, v53
    v_lshlrev_b32 v60, 16, v50
    v_and_b32 v61, 0xffff0000, v50
    v_lshlrev_b32 v140, 16, v54
    v_and_b32 v141, 0xffff0000, v54
    v_lshlrev_b32 v62, 16, v51
    v_and_b32 v63, 0xffff0000, v51
    v_lshlrev_b32 v142, 16, v55
    v_and_b32 v143, 0xffff0000, v55
    v_fma_f32 v56, v128, v13, v56
    v_fma_f32 v57, v129, v13, v57
    v_fma_f32 v58, v130, v13, v58
    v_fma_f32 v59, v131, v13, v59
    v_fma_f32 v60, v132, v13, v60
    v_fma_f32 v61, v133, v13, v61
    v_fma_f32 v62, v134, v13, v62
    v_fma_f32 v63, v135, v13, v63
    v_mul_f32 v56, v56, v136
    v_mul_f32 v57, v57, v137
    v_mul_f32 v58, v58, v138
    v_mul_f32 v59, v59, v139
    v_mul_f32 v60, v60, v140
    v_mul_f32 v61, v61, v141
    v_mul_f32 v62, v62, v142
    v_mul_f32 v63, v63, v143
    v_cvt_pk_bf16_f32 v72, v56, v57
    v_cvt_pk_bf16_f32 v73, v58, v59
    v_cvt_pk_bf16_f32 v74, v60, v61
    v_cvt_pk_bf16_f32 v75, v62, v63
    ds_write_b128 v30, v[72:75]
    s_waitcnt lgkmcnt(0)
    ds_write_b32 v10, v11
afm_tab_kernel_pollA:
    ds_read_b128 v[16:19], v12 offset:16
    s_waitcnt lgkmcnt(0)
    v_add3_u32 v16, v16, v17, v18
    v_add_u32 v16, v16, v19
    s_nop 0
    v_readfirstlane_b32 s46, v16
    s_cmp_eq_u32 s46, 4
    s_cbranch_scc1 afm_tab_kernel_pollA_ok
    s_sleep 2
    s_branch afm_tab_kernel_pollA
afm_tab_kernel_pollA_ok:
    ds_read_b128 v[72:75], v29 offset:0
    ds_read_b128 v[76:79], v29 offset:1024
    ds_read_b128 v[80:83], v29 offset:2048
    ds_read_b128 v[84:87], v29 offset:3072
    s_waitcnt vmcnt(0) lgkmcnt(0)
    s_barrier
    s_add_u32 s48, s48, 16
    s_cmp_ge_u32 s48, 1000
    s_cselect_b32 s46, 1000, 0
    s_sub_u32 s48, s48, s46
    s_add_u32 m0, s44, 36864
    s_lshl_b32 s46, s48, 8
    buffer_load_dwordx4 v120, s[16:19], s46 offen lds
    s_add_u32 s48, s48, 16
    s_cmp_ge_u32 s48, 1000
    s_cselect_b32 s46, 1000, 0
    s_sub_u32 s48, s48, s46
    s_add_u32 m0, s44, 40960
    s_lshl_b32 s46, s48, 8
    buffer_load_dwordx4 v120, s[16:19], s46 offen lds
    s_add_u32 s48, s48, 16
    s_cmp_ge_u32 s48, 1000
    s_cselect_b32 s46, 1000, 0
    s_sub_u32 s48, s48, s46
    s_add_u32 m0, s44, 45056
    s_lshl_b32 s46, s48, 8
    buffer_load_dwordx4 v120, s[16:19], s46 offen lds
    s_add_u32 s48, s48, 16
    s_cmp_ge_u32 s48, 1000
    s_cselect_b32 s46, 1000, 0
    s_sub_u32 s48, s48, s46
    s_add_u32 m0, s44, 49152
    s_lshl_b32 s46, s48, 8
    buffer_load_dwordx4 v120, s[16:19], s46 offen lds
    s_add_u32 s48, s48, 16
    s_cmp_ge_u32 s48, 1000
    s_cselect_b32 s46, 1000, 0
    s_sub_u32 s48, s48, s46
    s_add_u32 m0, s44, 53248
    s_lshl_b32 s46, s48, 8
    buffer_load_dwordx4 v120, s[16:19], s46 offen lds
    s_add_u32 s48, s48, 16
    s_cmp_ge_u32 s48, 1000
    s_cselect_b32 s46, 1000, 0
    s_sub_u32 s48, s48, s46
    s_add_u32 m0, s44, 57344
    s_lshl_b32 s46, s48, 8
    buffer_load_dwordx4 v120, s[16:19], s46 offen lds
    s_add_u32 s48, s48, 16
    s_cmp_ge_u32 s48, 1000
    s_cselect_b32 s46, 1000, 0
    s_sub_u32 s48, s48, s46
    s_add_u32 m0, s44, 61440
    s_lshl_b32 s46, s48, 8
    buffer_load_dwordx4 v120, s[16:19], s46 offen lds
    s_add_u32 s48, s48, 16
    s_cmp_ge_u32 s48, 1000
    s_cselect_b32 s46, 1000, 0
    s_sub_u32 s48, s48, s46
    s_add_u32 m0, s44, 65536
    s_lshl_b32 s46, s48, 8
    buffer_load_dwordx4 v120, s[16:19], s46 offen lds
    s_add_u32 s48, s48, 16
    s_cmp_ge_u32 s48, 1000
    s_cselect_b32 s46, 1000, 0
    s_sub_u32 s48, s48, s46
    s_add_u32 m0, s44, 69632
    s_lshl_b32 s46, s48, 8
    buffer_load_dwordx4 v120, s[16:19], s46 offen lds
    s_add_u32 s48, s48, 16
    s_cmp_ge_u32 s48, 1000
    s_cselect_b32 s46, 1000, 0
    s_sub_u32 s48, s48, s46
    s_add_u32 m0, s44, 73728
    s_lshl_b32 s46, s48, 8
    buffer_load_dwordx4 v120, s[16:19], s46 offen lds
    s_add_u32 s48, s48, 16
    s_cmp_ge_u32 s48, 1000
    s_cselect_b32 s46, 1000, 0
    s_sub_u32 s48, s48, s46
    s_add_u32 m0, s44, 77824
    s_lshl_b32 s46, s48, 8
    buffer_load_dwordx4 v120, s[16:19], s46 offen lds
    s_add_u32 s48, s48, 16
    s_cmp_ge_u32 s48, 1000
    s_cselect_b32 s46, 1000, 0
    s_sub_u32 s48, s48, s46
    s_add_u32 m0, s44, 81920
    s_lshl_b32 s46, s48, 8
    buffer_load_dwordx4 v120, s[16:19], s46 offen lds
    s_add_u32 s48, s48, 16
    s_cmp_ge_u32 s48, 1000
    s_cselect_b32 s46, 1000, 0
    s_sub_u32 s48, s48, s46
    s_add_u32 m0, s44, 86016
    s_lshl_b32 s46, s48, 8
    buffer_load_dwordx4 v120, s[16:19], s46 offen lds
    s_add_u32 s48, s48, 16
    s_cmp_ge_u32 s48, 1000
    s_cselect_b32 s46, 1000, 0
    s_sub_u32 s48, s48, s46
    s_add_u32 m0, s44, 90112
    s_lshl_b32 s46, s48, 8
    buffer_load_dwordx4 v120, s[16:19], s46 offen lds
    s_add_u32 s48, s48, 16
    s_cmp_ge_u32 s48, 1000
    s_cselect_b32 s46, 1000, 0
    s_sub_u32 s48, s48, s46
    s_add_u32 m0, s44, 94208
    s_lshl_b32 s46, s48, 8
    buffer_load_dwordx4 v120, s[16:19], s46 offen lds
    s_add_u32 s48, s48, 16
    s_cmp_ge_u32 s48, 1000
    s_cselect_b32 s46, 1000, 0
    s_sub_u32 s48, s48, s46
    s_add_u32 m0, s44, 98304
    s_lshl_b32 s46, s48, 8
    buffer_load_dwordx4 v120, s[16:19], s46 offen lds
    s_add_u32 s48, s48, 16
    s_cmp_ge_u32 s48, 1000
    s_cselect_b32 s46, 1000, 0
    s_sub_u32 s48, s48, s46
    s_add_u32 m0, s44, 102400
    s_lshl_b32 s46, s48, 8
    buffer_load_dwordx4 v120, s[16:19], s46 offen lds
    s_add_u32 s48, s48, 16
    s_cmp_ge_u32 s48, 1000
    s_cselect_b32 s46, 1000, 0
    s_sub_u32 s48, s48, s46
    s_add_u32 m0, s44, 106496
    s_lshl_b32 s46, s48, 8
    buffer_load_dwordx4 v120, s[16:19], s46 offen lds
    s_add_u32 s48, s48, 16
    s_cmp_ge_u32 s48, 1000
    s_cselect_b32 s46, 1000, 0
    s_sub_u32 s48, s48, s46
    s_add_u32 m0, s44, 110592
    s_lshl_b32 s46, s48, 8
    buffer_load_dwordx4 v120, s[16:19], s46 offen lds
    s_add_u32 s48, s48, 16
    s_cmp_ge_u32 s48, 1000
    s_cselect_b32 s46, 1000, 0
    s_sub_u32 s48, s48, s46
    s_add_u32 m0, s44, 114688
    s_lshl_b32 s46, s48, 8
    buffer_load_dwordx4 v120, s[16:19], s46 offen lds
    s_add_u32 s48, s48, 16
    s_cmp_ge_u32 s48, 1000
    s_cselect_b32 s46, 1000, 0
    s_sub_u32 s48, s48, s46
    s_add_u32 m0, s44, 118784
    s_lshl_b32 s46, s48, 8
    buffer_load_dwordx4 v120, s[16:19], s46 offen lds
    s_add_u32 s48, s48, 16
    s_cmp_ge_u32 s48, 1000
    s_cselect_b32 s46, 1000, 0
    s_sub_u32 s48, s48, s46
    s_add_u32 m0, s44, 122880
    s_lshl_b32 s46, s48, 8
    buffer_load_dwordx4 v120, s[16:19], s46 offen lds
    s_cmp_eq_u32 s50, 3
    s_cbranch_scc1 afm_tab_kernel_nolast
    s_cmp_eq_u32 s85, 7
    s_cbranch_scc1 afm_tab_kernel_nolast
    s_add_u32 s48, s48, 16
    s_cmp_ge_u32 s48, 1000
    s_cselect_b32 s46, 1000, 0
    s_sub_u32 s48, s48, s46
    s_add_u32 m0, s44, 126976
    s_lshl_b32 s46, s48, 8
    buffer_load_dwordx4 v120, s[16:19], s46 offen lds
afm_tab_kernel_nolast:
    v_lshlrev_b32 v66, 16, v64
    v_and_b32 v67, 0xffff0000, v64
    v_lshlrev_b32 v68, 16, v65
    v_and_b32 v69, 0xffff0000, v65
    v_mul_f32 v66, v66, |v68|
    v_fma_f32 v66, v67, |v69|, v66
    s_nop 1
    v_add_f32_dpp v66, v66, v66 row_ror:8 row_mask:0xf bank_mask:0xf
    s_nop 1
    v_add_f32_dpp v66, v66, v66 row_ror:4 row_mask:0xf bank_mask:0xf
    s_nop 1
    v_add_f32_dpp v66, v66, v66 row_ror:2 row_mask:0xf bank_mask:0xf
    s_nop 1
    v_add_f32_dpp v66, v66, v66 row_ror:1 row_mask:0xf bank_mask:0xf
    s_nop 1
    v_add_f32_dpp v66, v66, v66 row_bcast:15 row_mask:0xa bank_mask:0xf
    s_nop 1
    v_add_f32_dpp v66, v66, v66 row_bcast:31 row_mask:0xc bank_mask:0xf
    s_nop 1
    v_readlane_b32 s51, v66, 63
    s_mov_b32 s49, 0xbf38aa3b
    s_nop 1
    v_mov_b32 v70, s49
    v_mul_f32 v100, s51, v70
    v_mov_b32 v101, 0
    v_mov_b32 v102, 0
    v_mov_b32 v103, 0
    v_add_u32 v21, -16, v10
    s_waitcnt vmcnt(0)
    ds_write_b32 v21, v11
    v_xor_b32 v4, v2, v3
    v_lshlrev_b32 v4, 4, v4
    v_lshl_add_u32 v4, v3, 8, v4
    s_lshl_b32 s51, s50, 12
    v_add_u32 v4, s51, v4
    v_xor_b32 v5, 64, v4
    v_xor_b32 v6, 128, v4
    v_xor_b32 v7, 192, v4
    v_lshlrev_b32 v8, 12, v2
    v_lshl_add_u32 v8, v3, 3, v8
    s_lshl_b32 s51, s50, 7
    s_add_u32 s51, s51, 131072
    v_add_u32 v8, s51, v8
    v_add_u32 v20, 65536, v4
    v_add_u32 v21, 65536, v5
    v_add_u32 v22, 65536, v6
    v_add_u32 v23, 65536, v7
afm_tab_kernel_pollT:
    ds_read_b128 v[16:19], v12 offset:0
    s_waitcnt lgkmcnt(0)
    v_add3_u32 v16, v16, v17, v18
    v_add_u32 v16, v16, v19
    s_nop 0
    v_readfirstlane_b32 s46, v16
    s_cmp_eq_u32 s46, 4
    s_cbranch_scc1 afm_tab_kernel_pollT_ok
    s_sleep 2
    s_branch afm_tab_kernel_pollT
afm_tab_kernel_pollT_ok:
    s_setprio 2
    ds_read_b128 v[160:163], v4 offset:0
    ds_read_b128 v[164:167], v5 offset:0
    ds_read_b128 v[168:171], v6 offset:0
    ds_read_b128 v[172:175], v7 offset:0
    s_waitcnt lgkmcnt(0)
    v_mfma_f32_16x16x32_bf16 v[192:195], v[72:75], v[160:163], v[100:103]
    v_mfma_f32_16x16x32_bf16 v[192:195], v[76:79], v[164:167], v[192:195]
    v_mfma_f32_16x16x32_bf16 v[192:195], v[80:83], v[168:171], v[192:195]
    v_mfma_f32_16x16x32_bf16 v[192:195], v[84:87], v[172:175], v[192:195]
    ds_read_b128 v[176:179], v4 offset:16384
    ds_read_b128 v[180:183], v5 offset:16384
    ds_read_b128 v[184:187], v6 offset:16384
    ds_read_b128 v[188:191], v7 offset:16384
    s_nop 4
    ds_write_b64 v8, v[192:193] offset:0
    s_waitcnt lgkmcnt(0)
    v_mfma_f32_16x16x32_bf16 v[196:199], v[72:75], v[176:179], v[100:103]
    v_mfma_f32_16x16x32_bf16 v[196:199], v[76:79], v[180:183], v[196:199]
    v_mfma_f32_16x16x32_bf16 v[196:199], v[80:83], v[184:187], v[196:199]
    v_mfma_f32_16x16x32_bf16 v[196:199], v[84:87], v[188:191], v[196:199]
    ds_read_b128 v[160:163], v4 offset:32768
    ds_read_b128 v[164:167], v5 offset:32768
    ds_read_b128 v[168:171], v6 offset:32768
    ds_read_b128 v[172:175], v7 offset:32768
    s_nop 4
    ds_write_b64 v8, v[196:197] offset:512
    s_waitcnt lgkmcnt(0)
    v_mfma_f32_16x16x32_bf16 v[192:195], v[72:75], v[160:163], v[100:103]
    v_mfma_f32_16x16x32_bf16 v[192:195], v[76:79], v[164:167], v[192:195]
    v_mfma_f32_16x16x32_bf16 v[192:195], v[80:83], v[168:171], v[192:195]
    v_mfma_f32_16x16x32_bf16 v[192:195], v[84:87], v[172:175], v[192:195]
    ds_read_b128 v[176:179], v4 offset:49152
    ds_read_b128 v[180:183], v5 offset:49152
    ds_read_b128 v[184:187], v6 offset:49152
    ds_read_b128 v[188:191], v7 offset:49152
    s_nop 4
    ds_write_b64 v8, v[192:193] offset:1024
    s_waitcnt lgkmcnt(0)
    v_mfma_f32_16x16x32_bf16 v[196:199], v[72:75], v[176:179], v[100:103]
    v_mfma_f32_16x16x32_bf16 v[196:199], v[76:79], v[180:183], v[196:199]
    v_mfma_f32_16x16x32_bf16 v[196:199], v[80:83], v[184:187], v[196:199]
    v_mfma_f32_16x16x32_bf16 v[196:199], v[84:87], v[188:191], v[196:199]
    ds_read_b128 v[160:163], v20 offset:0
    ds_read_b128 v[164:167], v21 offset:0
    ds_read_b128 v[168:171], v22 offset:0
    ds_read_b128 v[172:175], v23 offset:0
    s_nop 4
    ds_write_b64 v8, v[196:197] offset:1536
    s_waitcnt lgkmcnt(0)
    v_mfma_f32_16x16x32_bf16 v[192:195], v[72:75], v[160:163], v[100:103]
    v_mfma_f32_16x16x32_bf16 v[192:195], v[76:79], v[164:167], v[192:195]
    v_mfma_f32_16x16x32_bf16 v[192:195], v[80:83], v[168:171], v[192:195]
    v_mfma_f32_16x16x32_bf16 v[192:195], v[84:87], v[172:175], v[192:195]
    ds_read_b128 v[176:179], v20 offset:16384
    ds_read_b128 v[180:183], v21 offset:16384
    ds_read_b128 v[184:187], v22 offset:16384
    ds_read_b128 v[188:191], v23 offset:16384
    s_nop 4
    ds_write_b64 v8, v[192:193] offset:2048
    s_waitcnt lgkmcnt(0)
    v_mfma_f32_16x16x32_bf16 v[196:199], v[72:75], v[176:179], v[100:103]
    v_mfma_f32_16x16x32_bf16 v[196:199], v[76:79], v[180:183], v[196:199]
    v_mfma_f32_16x16x32_bf16 v[196:199], v[80:83], v[184:187], v[196:199]
    v_mfma_f32_16x16x32_bf16 v[196:199], v[84:87], v[188:191], v[196:199]
    ds_read_b128 v[160:163], v20 offset:32768
    ds_read_b128 v[164:167], v21 offset:32768
    ds_read_b128 v[168:171], v22 offset:32768
    ds_read_b128 v[172:175], v23 offset:32768
    s_nop 4
    ds_write_b64 v8, v[196:197] offset:2560
    s_waitcnt lgkmcnt(0)
    v_mfma_f32_16x16x32_bf16 v[192:195], v[72:75], v[160:163], v[100:103]
    v_mfma_f32_16x16x32_bf16 v[192:195], v[76:79], v[164:167], v[192:195]
    v_mfma_f32_16x16x32_bf16 v[192:195], v[80:83], v[168:171], v[192:195]
    v_mfma_f32_16x16x32_bf16 v[192:195], v[84:87], v[172:175], v[192:195]
    ds_read_b128 v[176:179], v20 offset:49152
    ds_read_b128 v[180:183], v21 offset:49152
    ds_read_b128 v[184:187], v22 offset:49152
    ds_read_b128 v[188:191], v23 offset:49152
    s_nop 4
    ds_write_b64 v8, v[192:193] offset:3072
    s_waitcnt lgkmcnt(0)
    v_mfma_f32_16x16x32_bf16 v[196:199], v[72:75], v[176:179], v[100:103]
    v_mfma_f32_16x16x32_bf16 v[196:199], v[76:79], v[180:183], v[196:199]
    v_mfma_f32_16x16x32_bf16 v[196:199], v[80:83], v[184:187], v[196:199]
    v_mfma_f32_16x16x32_bf16 v[196:199], v[84:87], v[188:191], v[196:199]
    s_nop 7
    ds_write_b64 v8, v[196:197] offset:3584
    v_add_u32 v22, 64, v10
    s_waitcnt lgkmcnt(0)
    ds_write_b32 v22, v11
    s_setprio 0
    s_mov_b32 s56, s52
    s_mov_b32 s57, s53
    s_mov_b32 s58, 425984
    s_mov_b32 s59, 0x00020000
    s_mov_b32 s36, s6
    s_mov_b32 s37, s7
    s_mov_b32 s38, 0x10000000
    s_mov_b32 s39, 0x00020000
    s_mov_b32 s41, 165191050
    s_movk_i32 s42, 1000
    s_movk_i32 s43, 508
    s_mov_b32 s45, 0xf149f2ca
    v_lshlrev_b32 v89, 4, v0
    v_lshlrev_b32 v91, 2, v0
    s_cmp_lg_u32 s50, 0
    s_cbranch_scc1 afm_tab_kernel_waitI
    s_load_dwordx2 s[60:61], s[0:1], 72
    s_waitcnt lgkmcnt(0)
    s_mov_b32 s62, 256
    s_mov_b32 s63, 0x00020000
    s_lshr_b32 s46, s40, 2
    s_and_b32 s46, s46, 3
    s_lshl_b32 s46, s46, 6
    v_mov_b32 v16, s46
    s_mov_b32 s51, 0
    s_mov_b32 s49, 2
afm_tab_kernel_pollG:
    s_mov_b64 exec, 1
    buffer_load_dword v17, v16, s[60:63], 0 offen sc1
    s_mov_b64 exec, -1
    s_waitcnt vmcnt(0)
    v_readfirstlane_b32 s46, v17
    s_cmp_eq_u32 s46, 6
    s_cbranch_scc1 afm_tab_kernel_gotG
    s_sleep 8
    s_add_u32 s51, s51, 1
    s_cmp_lt_u32 s51, 4096
    s_cbranch_scc1 afm_tab_kernel_pollG
    s_branch afm_tab_kernel_pubI
afm_tab_kernel_gotG:
    s_mul_i32 s46, s40, 65
    s_add_u32 s46, s46, 2097152
    buffer_load_dword v24, v91, s[36:39], s46 offen sc1
    s_add_u32 s46, s46, 65536
    buffer_load_dword v25, v91, s[36:39], s46 offen sc1
    s_add_u32 s46, s46, 65536
    buffer_load_dword v26, v91, s[36:39], s46 offen sc1
    s_add_u32 s46, s46, 65536
    buffer_load_dword v27, v91, s[36:39], s46 offen sc1
    s_add_u32 s46, s46, 65536
    buffer_load_dword v28, v91, s[36:39], s46 offen sc1
    s_add_u32 s46, s46, 65536
    buffer_load_dword v29, v91, s[36:39], s46 offen sc1
    v_lshlrev_b32 v18, 10, v0
    s_add_u32 s46, s40, 3145728
    s_mov_b64 exec, 0x3f
    buffer_load_dword v19, v18, s[36:39], s46 offen sc1
    s_mov_b64 exec, -1
    v_add_u32 v16, 160000, v91
    s_waitcnt vmcnt(0)
    ds_write_b32 v16, v24 offset:0
    ds_write_b32 v16, v25 offset:256
    ds_write_b32 v16, v26 offset:512
    ds_write_b32 v16, v27 offset:768
    ds_write_b32 v16, v28 offset:1024
    ds_write_b32 v16, v29 offset:1280
    v_readlane_b32 s64, v19, 0
    v_readlane_b32 s65, v19, 1
    v_readlane_b32 s66, v19, 2
    v_readlane_b32 s67, v19, 3
    v_readlane_b32 s68, v19, 4
    v_readlane_b32 s69, v19, 5
    s_mov_b32 s49, 1
    s_mov_b32 s70, 0
    v_mov_b32 v17, 0
    s_cmp_gt_u32 s64, 128
    s_cselect_b32 s49, 2, s49
    v_writelane_b32 v17, s70, 0
    s_add_u32 s70, s70, s64
    s_cmp_gt_u32 s65, 128
    s_cselect_b32 s49, 2, s49
    v_writelane_b32 v17, s70, 1
    s_add_u32 s70, s70, s65
    s_cmp_gt_u32 s66, 128
    s_cselect_b32 s49, 2, s49
    v_writelane_b32 v17, s70, 2
    s_add_u32 s70, s70, s66
    s_cmp_gt_u32 s67, 128
    s_cselect_b32 s49, 2, s49
    v_writelane_b32 v17, s70, 3
    s_add_u32 s70, s70, s67
    s_cmp_gt_u32 s68, 128
    s_cselect_b32 s49, 2, s49
    v_writelane_b32 v17, s70, 4
    s_add_u32 s70, s70, s68
    s_cmp_gt_u32 s69, 128
    s_cselect_b32 s49, 2, s49
    v_writelane_b32 v17, s70, 5
    s_add_u32 s70, s70, s69
    v_writelane_b32 v17, s70, 6
    s_cmp_gt_u32 s70, 512
    s_cselect_b32 s49, 2, s49
    v_add_u32 v18, 130864, v91
    s_mov_b64 exec, 0x7f
    ds_write_b32 v18, v17
    s_mov_b64 exec, -1
afm_tab_kernel_pubI:
    v_mov_b32 v17, s49
    s_waitcnt lgkmcnt(0)
    ds_write_b32 v12, v17 offset:32
afm_tab_kernel_waitI:
    ds_read_b32 v16, v12 offset:32
    s_waitcnt lgkmcnt(0)
    v_readfirstlane_b32 s49, v16
    s_cmp_lg_u32 s49, 0
    s_cbranch_scc1 afm_tab_kernel_gotI
    s_sleep 2
    s_branch afm_tab_kernel_waitI
afm_tab_kernel_gotI:
    s_cmp_lg_u32 s49, 1
    s_cbranch_scc1 afm_tab_kernel_hskip
    ds_read_b128 v[16:19], v12 offset:48
    ds_read_b128 v[20:23], v12 offset:64
    s_waitcnt lgkmcnt(0)
    v_readfirstlane_b32 s65, v17
    v_readfirstlane_b32 s66, v18
    v_readfirstlane_b32 s67, v19
    v_readfirstlane_b32 s68, v20
    v_readfirstlane_b32 s69, v21
    v_readfirstlane_b32 s70, v22
    s_lshl_b32 s46, s50, 7
    v_add_u32 v24, s46, v0
    v_mov_b32 v26, 0
    v_cmp_le_u32 s[72:73], s65, v24
    v_cmp_le_u32 s[74:75], s66, v24
    v_cmp_le_u32 s[76:77], s67, v24
    v_cmp_le_u32 s[78:79], s68, v24
    v_cmp_le_u32 s[80:81], s69, v24
    v_addc_co_u32 v26, vcc, 0, v26, s[72:73]
    v_addc_co_u32 v26, vcc, 0, v26, s[74:75]
    v_addc_co_u32 v26, vcc, 0, v26, s[76:77]
    v_addc_co_u32 v26, vcc, 0, v26, s[78:79]
    v_addc_co_u32 v26, vcc, 0, v26, s[80:81]
    v_lshlrev_b32 v28, 2, v26
    v_add_u32 v28, 130864, v28
    ds_read_b32 v30, v28
    v_cmp_gt_u32 s[54:55], s70, v24
    v_add_u32 v25, s46, v0
    v_add_u32 v25, 64, v25
    v_mov_b32 v27, 0
    v_cmp_le_u32 s[72:73], s65, v25
    v_cmp_le_u32 s[74:75], s66, v25
    v_cmp_le_u32 s[76:77], s67, v25
    v_cmp_le_u32 s[78:79], s68, v25
    v_cmp_le_u32 s[80:81], s69, v25
    v_addc_co_u32 v27, vcc, 0, v27, s[72:73]
    v_addc_co_u32 v27, vcc, 0, v27, s[74:75]
    v_addc_co_u32 v27, vcc, 0, v27, s[76:77]
    v_addc_co_u32 v27, vcc, 0, v27, s[78:79]
    v_addc_co_u32 v27, vcc, 0, v27, s[80:81]
    v_lshlrev_b32 v29, 2, v27
    v_add_u32 v29, 130864, v29
    ds_read_b32 v31, v29
    v_cmp_gt_u32 s[82:83], s70, v25
    s_waitcnt lgkmcnt(0)
    v_sub_u32 v28, v24, v30
    v_lshlrev_b32 v28, 1, v28
    v_lshl_add_u32 v28, v26, 8, v28
    v_cndmask_b32 v28, 0, v28, s[54:55]
    v_add_u32 v28, 160000, v28
    ds_read_u16 v30, v28
    v_sub_u32 v29, v25, v31
    v_lshlrev_b32 v29, 1, v29
    v_lshl_add_u32 v29, v27, 8, v29
    v_cndmask_b32 v29, 0, v29, s[82:83]
    v_add_u32 v29, 160000, v29
    ds_read_u16 v31, v29
    s_mov_b32 s46, 17758
    s_waitcnt lgkmcnt(0)
    v_mad_u32_u24 v104, v26, s46, v30
    v_cndmask_b32 v104, 0, v104, s[54:55]
    v_mad_u32_u24 v105, v27, s46, v31
    v_cndmask_b32 v105, 0, v105, s[82:83]
    v_mul_hi_u32 v112, v104, s41
    v_lshlrev_b32 v114, 2, v104
    v_mul_u32_u24 v113, 26, v112
    v_mul_u32_u24 v112, 104, v112
    v_sub_u32 v108, v104, v113
    buffer_load_dword v106, v114, s[56:59], 0 offen
    buffer_load_dwordx4 v[128:131], v112, s[56:59], 0 offen offset:0
    buffer_load_dwordx4 v[132:135], v112, s[56:59], 0 offen offset:16
    buffer_load_dwordx4 v[136:139], v112, s[56:59], 0 offen offset:32
    buffer_load_dwordx4 v[140:143], v112, s[56:59], 0 offen offset:48
    buffer_load_dwordx4 v[144:147], v112, s[56:59], 0 offen offset:64
    buffer_load_dwordx4 v[148:151], v112, s[56:59], 0 offen offset:80
    buffer_load_dwordx2 v[152:153], v112, s[56:59], 0 offen offset:96
    v_mul_hi_u32 v112, v105, s41
    v_lshlrev_b32 v114, 2, v105
    v_mul_u32_u24 v113, 26, v112
    v_mul_u32_u24 v112, 104, v112
    v_sub_u32 v109, v105, v113
    buffer_load_dword v107, v114, s[56:59], 0 offen
    buffer_load_dwordx4 v[160:163], v112, s[56:59], 0 offen offset:0
    buffer_load_dwordx4 v[164:167], v112, s[56:59], 0 offen offset:16
    buffer_load_dwordx4 v[168:171], v112, s[56:59], 0 offen offset:32
    buffer_load_dwordx4 v[172:175], v112, s[56:59], 0 offen offset:48
    buffer_load_dwordx4 v[176:179], v112, s[56:59], 0 offen offset:64
    buffer_load_dwordx4 v[180:183], v112, s[56:59], 0 offen offset:80
    buffer_load_dwordx2 v[184:185], v112, s[56:59], 0 offen offset:96
    s_waitcnt vmcnt(8)
    v_and_b32 v112, 3, v106
    v_sub_u32 v114, s43, v112
    v_mul_u32_u24 v112, 2052, v112
    v_add_u32 v112, 147712, v112
    v_cmp_le_u32 s[64:65], 0, v108
    v_cmp_le_u32 s[66:67], 1, v108
    v_cmp_le_u32 s[68:69], 2, v108
    v_subb_co_u32 v128, vcc, v128, v106, s[64:65]
    v_add_u32 v113, s42, v128
    v_min_u32 v128, v128, v113
    v_addc_co_u32 v128, vcc, 0, v128, s[64:65]
    v_min_u32 v128, v114, v128
    v_lshl_add_u32 v128, v128, 2, v112
    v_cmp_le_u32 s[70:71], 3, v108
    v_subb_co_u32 v129, vcc, v129, v106, s[66:67]
    v_add_u32 v113, s42, v129
    v_min_u32 v129, v129, v113
    v_addc_co_u32 v129, vcc, 0, v129, s[66:67]
    v_min_u32 v129, v114, v129
    v_lshl_add_u32 v129, v129, 2, v112
    v_cmp_le_u32 s[64:65], 4, v108
    v_subb_co_u32 v130, vcc, v130, v106, s[68:69]
    v_add_u32 v113, s42, v130
    v_min_u32 v130, v130, v113
    v_addc_co_u32 v130, vcc, 0, v130, s[68:69]
    v_min_u32 v130, v114, v130
    v_lshl_add_u32 v130, v130, 2, v112
    v_cmp_le_u32 s[66:67], 5, v108
    v_subb_co_u32 v131, vcc, v131, v106, s[70:71]
    v_add_u32 v113, s42, v131
    v_min_u32 v131, v131, v113
    v_addc_co_u32 v131, vcc, 0, v131, s[70:71]
    v_min_u32 v131, v114, v131
    v_lshl_add_u32 v131, v131, 2, v112
    v_cmp_le_u32 s[68:69], 6, v108
    v_subb_co_u32 v132, vcc, v132, v106, s[64:65]
    v_add_u32 v113, s42, v132
    v_min_u32 v132, v132, v113
    v_addc_co_u32 v132, vcc, 0, v132, s[64:65]
    v_min_u32 v132, v114, v132
    v_lshl_add_u32 v132, v132, 2, v112
    v_cmp_le_u32 s[70:71], 7, v108
    v_subb_co_u32 v133, vcc, v133, v106, s[66:67]
    v_add_u32 v113, s42, v133
    v_min_u32 v133, v133, v113
    v_addc_co_u32 v133, vcc, 0, v133, s[66:67]
    v_min_u32 v133, v114, v133
    v_lshl_add_u32 v133, v133, 2, v112
    v_cmp_le_u32 s[64:65], 8, v108
    v_subb_co_u32 v134, vcc, v134, v106, s[68:69]
    v_add_u32 v113, s42, v134
    v_min_u32 v134, v134, v113
    v_addc_co_u32 v134, vcc, 0, v134, s[68:69]
    v_min_u32 v134, v114, v134
    v_lshl_add_u32 v134, v134, 2, v112
    v_cmp_le_u32 s[66:67], 9, v108
    v_subb_co_u32 v135, vcc, v135, v106, s[70:71]
    v_add_u32 v113, s42, v135
    v_min_u32 v135, v135, v113
    v_addc_co_u32 v135, vcc, 0, v135, s[70:71]
    v_min_u32 v135, v114, v135
    v_lshl_add_u32 v135, v135, 2, v112
    v_cmp_le_u32 s[68:69], 10, v108
    v_subb_co_u32 v136, vcc, v136, v106, s[64:65]
    v_add_u32 v113, s42, v136
    v_min_u32 v136, v136, v113
    v_addc_co_u32 v136, vcc, 0, v136, s[64:65]
    v_min_u32 v136, v114, v136
    v_lshl_add_u32 v136, v136, 2, v112
    v_cmp_le_u32 s[70:71], 11, v108
    v_subb_co_u32 v137, vcc, v137, v106, s[66:67]
    v_add_u32 v113, s42, v137
    v_min_u32 v137, v137, v113
    v_addc_co_u32 v137, vcc, 0, v137, s[66:67]
    v_min_u32 v137, v114, v137
    v_lshl_add_u32 v137, v137, 2, v112
    v_cmp_le_u32 s[64:65], 12, v108
    v_subb_co_u32 v138, vcc, v138, v106, s[68:69]
    v_add_u32 v113, s42, v138
    v_min_u32 v138, v138, v113
    v_addc_co_u32 v138, vcc, 0, v138, s[68:69]
    v_min_u32 v138, v114, v138
    v_lshl_add_u32 v138, v138, 2, v112
    v_cmp_le_u32 s[66:67], 13, v108
    v_subb_co_u32 v139, vcc, v139, v106, s[70:71]
    v_add_u32 v113, s42, v139
    v_min_u32 v139, v139, v113
    v_addc_co_u32 v139, vcc, 0, v139, s[70:71]
    v_min_u32 v139, v114, v139
    v_lshl_add_u32 v139, v139, 2, v112
    v_cmp_le_u32 s[68:69], 14, v108
    v_subb_co_u32 v140, vcc, v140, v106, s[64:65]
    v_add_u32 v113, s42, v140
    v_min_u32 v140, v140, v113
    v_addc_co_u32 v140, vcc, 0, v140, s[64:65]
    v_min_u32 v140, v114, v140
    v_lshl_add_u32 v140, v140, 2, v112
    v_cmp_le_u32 s[70:71], 15, v108
    v_subb_co_u32 v141, vcc, v141, v106, s[66:67]
    v_add_u32 v113, s42, v141
    v_min_u32 v141, v141, v113
    v_addc_co_u32 v141, vcc, 0, v141, s[66:67]
    v_min_u32 v141, v114, v141
    v_lshl_add_u32 v141, v141, 2, v112
    v_cmp_le_u32 s[64:65], 16, v108
    v_subb_co_u32 v142, vcc, v142, v106, s[68:69]
    v_add_u32 v113, s42, v142
    v_min_u32 v142, v142, v113
    v_addc_co_u32 v142, vcc, 0, v142, s[68:69]
    v_min_u32 v142, v114, v142
    v_lshl_add_u32 v142, v142, 2, v112
    v_cmp_le_u32 s[66:67], 17, v108
    v_subb_co_u32 v143, vcc, v143, v106, s[70:71]
    v_add_u32 v113, s42, v143
    v_min_u32 v143, v143, v113
    v_addc_co_u32 v143, vcc, 0, v143, s[70:71]
    v_min_u32 v143, v114, v143
    v_lshl_add_u32 v143, v143, 2, v112
    v_cmp_le_u32 s[68:69], 18, v108
    v_subb_co_u32 v144, vcc, v144, v106, s[64:65]
    v_add_u32 v113, s42, v144
    v_min_u32 v144, v144, v113
    v_addc_co_u32 v144, vcc, 0, v144, s[64:65]
    v_min_u32 v144, v114, v144
    v_lshl_add_u32 v144, v144, 2, v112
    v_cmp_le_u32 s[70:71], 19, v108
    v_subb_co_u32 v145, vcc, v145, v106, s[66:67]
    v_add_u32 v113, s42, v145
    v_min_u32 v145, v145, v113
    v_addc_co_u32 v145, vcc, 0, v145, s[66:67]
    v_min_u32 v145, v114, v145
    v_lshl_add_u32 v145, v145, 2, v112
    v_cmp_le_u32 s[64:65], 20, v108
    v_subb_co_u32 v146, vcc, v146, v106, s[68:69]
    v_add_u32 v113, s42, v146
    v_min_u32 v146, v146, v113
    v_addc_co_u32 v146, vcc, 0, v146, s[68:69]
    v_min_u32 v146, v114, v146
    v_lshl_add_u32 v146, v146, 2, v112
    v_cmp_le_u32 s[66:67], 21, v108
    v_subb_co_u32 v147, vcc, v147, v106, s[70:71]
    v_add_u32 v113, s42, v147
    v_min_u32 v147, v147, v113
    v_addc_co_u32 v147, vcc, 0, v147, s[70:71]
    v_min_u32 v147, v114, v147
    v_lshl_add_u32 v147, v147, 2, v112
    v_cmp_le_u32 s[68:69], 22, v108
    v_subb_co_u32 v148, vcc, v148, v106, s[64:65]
    v_add_u32 v113, s42, v148
    v_min_u32 v148, v148, v113
    v_addc_co_u32 v148, vcc, 0, v148, s[64:65]
    v_min_u32 v148, v114, v148
    v_lshl_add_u32 v148, v148, 2, v112
    v_cmp_le_u32 s[70:71], 23, v108
    v_subb_co_u32 v149, vcc, v149, v106, s[66:67]
    v_add_u32 v113, s42, v149
    v_min_u32 v149, v149, v113
    v_addc_co_u32 v149, vcc, 0, v149, s[66:67]
    v_min_u32 v149, v114, v149
    v_lshl_add_u32 v149, v149, 2, v112
    v_cmp_le_u32 s[64:65], 24, v108
    v_subb_co_u32 v150, vcc, v150, v106, s[68:69]
    v_add_u32 v113, s42, v150
    v_min_u32 v150, v150, v113
    v_addc_co_u32 v150, vcc, 0, v150, s[68:69]
    v_min_u32 v150, v114, v150
    v_lshl_add_u32 v150, v150, 2, v112
    v_cmp_le_u32 s[66:67], 25, v108
    v_subb_co_u32 v151, vcc, v151, v106, s[70:71]
    v_add_u32 v113, s42, v151
    v_min_u32 v151, v151, v113
    v_addc_co_u32 v151, vcc, 0, v151, s[70:71]
    v_min_u32 v151, v114, v151
    v_lshl_add_u32 v151, v151, 2, v112
    v_subb_co_u32 v152, vcc, v152, v106, s[64:65]
    v_add_u32 v113, s42, v152
    v_min_u32 v152, v152, v113
    v_addc_co_u32 v152, vcc, 0, v152, s[64:65]
    v_min_u32 v152, v114, v152
    v_lshl_add_u32 v152, v152, 2, v112
    v_subb_co_u32 v153, vcc, v153, v106, s[66:67]
    v_add_u32 v113, s42, v153
    v_min_u32 v153, v153, v113
    v_addc_co_u32 v153, vcc, 0, v153, s[66:67]
    v_min_u32 v153, v114, v153
    v_lshl_add_u32 v153, v153, 2, v112
    s_waitcnt vmcnt(0)
    v_and_b32 v112, 3, v107
    v_sub_u32 v114, s43, v112
    v_mul_u32_u24 v112, 2052, v112
    v_add_u32 v112, 147712, v112
    v_cmp_le_u32 s[64:65], 0, v109
    v_cmp_le_u32 s[66:67], 1, v109
    v_cmp_le_u32 s[68:69], 2, v109
    v_subb_co_u32 v160, vcc, v160, v107, s[64:65]
    v_add_u32 v113, s42, v160
    v_min_u32 v160, v160, v113
    v_addc_co_u32 v160, vcc, 0, v160, s[64:65]
    v_min_u32 v160, v114, v160
    v_lshl_add_u32 v160, v160, 2, v112
    v_cmp_le_u32 s[70:71], 3, v109
    v_subb_co_u32 v161, vcc, v161, v107, s[66:67]
    v_add_u32 v113, s42, v161
    v_min_u32 v161, v161, v113
    v_addc_co_u32 v161, vcc, 0, v161, s[66:67]
    v_min_u32 v161, v114, v161
    v_lshl_add_u32 v161, v161, 2, v112
    v_cmp_le_u32 s[64:65], 4, v109
    v_subb_co_u32 v162, vcc, v162, v107, s[68:69]
    v_add_u32 v113, s42, v162
    v_min_u32 v162, v162, v113
    v_addc_co_u32 v162, vcc, 0, v162, s[68:69]
    v_min_u32 v162, v114, v162
    v_lshl_add_u32 v162, v162, 2, v112
    v_cmp_le_u32 s[66:67], 5, v109
    v_subb_co_u32 v163, vcc, v163, v107, s[70:71]
    v_add_u32 v113, s42, v163
    v_min_u32 v163, v163, v113
    v_addc_co_u32 v163, vcc, 0, v163, s[70:71]
    v_min_u32 v163, v114, v163
    v_lshl_add_u32 v163, v163, 2, v112
    v_cmp_le_u32 s[68:69], 6, v109
    v_subb_co_u32 v164, vcc, v164, v107, s[64:65]
    v_add_u32 v113, s42, v164
    v_min_u32 v164, v164, v113
    v_addc_co_u32 v164, vcc, 0, v164, s[64:65]
    v_min_u32 v164, v114, v164
    v_lshl_add_u32 v164, v164, 2, v112
    v_cmp_le_u32 s[70:71], 7, v109
    v_subb_co_u32 v165, vcc, v165, v107, s[66:67]
    v_add_u32 v113, s42, v165
    v_min_u32 v165, v165, v113
    v_addc_co_u32 v165, vcc, 0, v165, s[66:67]
    v_min_u32 v165, v114, v165
    v_lshl_add_u32 v165, v165, 2, v112
    v_cmp_le_u32 s[64:65], 8, v109
    v_subb_co_u32 v166, vcc, v166, v107, s[68:69]
    v_add_u32 v113, s42, v166
    v_min_u32 v166, v166, v113
    v_addc_co_u32 v166, vcc, 0, v166, s[68:69]
    v_min_u32 v166, v114, v166
    v_lshl_add_u32 v166, v166, 2, v112
    v_cmp_le_u32 s[66:67], 9, v109
    v_subb_co_u32 v167, vcc, v167, v107, s[70:71]
    v_add_u32 v113, s42, v167
    v_min_u32 v167, v167, v113
    v_addc_co_u32 v167, vcc, 0, v167, s[70:71]
    v_min_u32 v167, v114, v167
    v_lshl_add_u32 v167, v167, 2, v112
    v_cmp_le_u32 s[68:69], 10, v109
    v_subb_co_u32 v168, vcc, v168, v107, s[64:65]
    v_add_u32 v113, s42, v168
    v_min_u32 v168, v168, v113
    v_addc_co_u32 v168, vcc, 0, v168, s[64:65]
    v_min_u32 v168, v114, v168
    v_lshl_add_u32 v168, v168, 2, v112
    v_cmp_le_u32 s[70:71], 11, v109
    v_subb_co_u32 v169, vcc, v169, v107, s[66:67]
    v_add_u32 v113, s42, v169
    v_min_u32 v169, v169, v113
    v_addc_co_u32 v169, vcc, 0, v169, s[66:67]
    v_min_u32 v169, v114, v169
    v_lshl_add_u32 v169, v169, 2, v112
    v_cmp_le_u32 s[64:65], 12, v109
    v_subb_co_u32 v170, vcc, v170, v107, s[68:69]
    v_add_u32 v113, s42, v170
    v_min_u32 v170, v170, v113
    v_addc_co_u32 v170, vcc, 0, v170, s[68:69]
    v_min_u32 v170, v114, v170
    v_lshl_add_u32 v170, v170, 2, v112
    v_cmp_le_u32 s[66:67], 13, v109
    v_subb_co_u32 v171, vcc, v171, v107, s[70:71]
    v_add_u32 v113, s42, v171
    v_min_u32 v171, v171, v113
    v_addc_co_u32 v171, vcc, 0, v171, s[70:71]
    v_min_u32 v171, v114, v171
    v_lshl_add_u32 v171, v171, 2, v112
    v_cmp_le_u32 s[68:69], 14, v109
    v_subb_co_u32 v172, vcc, v172, v107, s[64:65]
    v_add_u32 v113, s42, v172
    v_min_u32 v172, v172, v113
    v_addc_co_u32 v172, vcc, 0, v172, s[64:65]
    v_min_u32 v172, v114, v172
    v_lshl_add_u32 v172, v172, 2, v112
    v_cmp_le_u32 s[70:71], 15, v109
    v_subb_co_u32 v173, vcc, v173, v107, s[66:67]
    v_add_u32 v113, s42, v173
    v_min_u32 v173, v173, v113
    v_addc_co_u32 v173, vcc, 0, v173, s[66:67]
    v_min_u32 v173, v114, v173
    v_lshl_add_u32 v173, v173, 2, v112
    v_cmp_le_u32 s[64:65], 16, v109
    v_subb_co_u32 v174, vcc, v174, v107, s[68:69]
    v_add_u32 v113, s42, v174
    v_min_u32 v174, v174, v113
    v_addc_co_u32 v174, vcc, 0, v174, s[68:69]
    v_min_u32 v174, v114, v174
    v_lshl_add_u32 v174, v174, 2, v112
    v_cmp_le_u32 s[66:67], 17, v109
    v_subb_co_u32 v175, vcc, v175, v107, s[70:71]
    v_add_u32 v113, s42, v175
    v_min_u32 v175, v175, v113
    v_addc_co_u32 v175, vcc, 0, v175, s[70:71]
    v_min_u32 v175, v114, v175
    v_lshl_add_u32 v175, v175, 2, v112
    v_cmp_le_u32 s[68:69], 18, v109
    v_subb_co_u32 v176, vcc, v176, v107, s[64:65]
    v_add_u32 v113, s42, v176
    v_min_u32 v176, v176, v113
    v_addc_co_u32 v176, vcc, 0, v176, s[64:65]
    v_min_u32 v176, v114, v176
    v_lshl_add_u32 v176, v176, 2, v112
    v_cmp_le_u32 s[70:71], 19, v109
    v_subb_co_u32 v177, vcc, v177, v107, s[66:67]
    v_add_u32 v113, s42, v177
    v_min_u32 v177, v177, v113
    v_addc_co_u32 v177, vcc, 0, v177, s[66:67]
    v_min_u32 v177, v114, v177
    v_lshl_add_u32 v177, v177, 2, v112
    v_cmp_le_u32 s[64:65], 20, v109
    v_subb_co_u32 v178, vcc, v178, v107, s[68:69]
    v_add_u32 v113, s42, v178
    v_min_u32 v178, v178, v113
    v_addc_co_u32 v178, vcc, 0, v178, s[68:69]
    v_min_u32 v178, v114, v178
    v_lshl_add_u32 v178, v178, 2, v112
    v_cmp_le_u32 s[66:67], 21, v109
    v_subb_co_u32 v179, vcc, v179, v107, s[70:71]
    v_add_u32 v113, s42, v179
    v_min_u32 v179, v179, v113
    v_addc_co_u32 v179, vcc, 0, v179, s[70:71]
    v_min_u32 v179, v114, v179
    v_lshl_add_u32 v179, v179, 2, v112
    v_cmp_le_u32 s[68:69], 22, v109
    v_subb_co_u32 v180, vcc, v180, v107, s[64:65]
    v_add_u32 v113, s42, v180
    v_min_u32 v180, v180, v113
    v_addc_co_u32 v180, vcc, 0, v180, s[64:65]
    v_min_u32 v180, v114, v180
    v_lshl_add_u32 v180, v180, 2, v112
    v_cmp_le_u32 s[70:71], 23, v109
    v_subb_co_u32 v181, vcc, v181, v107, s[66:67]
    v_add_u32 v113, s42, v181
    v_min_u32 v181, v181, v113
    v_addc_co_u32 v181, vcc, 0, v181, s[66:67]
    v_min_u32 v181, v114, v181
    v_lshl_add_u32 v181, v181, 2, v112
    v_cmp_le_u32 s[64:65], 24, v109
    v_subb_co_u32 v182, vcc, v182, v107, s[68:69]
    v_add_u32 v113, s42, v182
    v_min_u32 v182, v182, v113
    v_addc_co_u32 v182, vcc, 0, v182, s[68:69]
    v_min_u32 v182, v114, v182
    v_lshl_add_u32 v182, v182, 2, v112
    v_cmp_le_u32 s[66:67], 25, v109
    v_subb_co_u32 v183, vcc, v183, v107, s[70:71]
    v_add_u32 v113, s42, v183
    v_min_u32 v183, v183, v113
    v_addc_co_u32 v183, vcc, 0, v183, s[70:71]
    v_min_u32 v183, v114, v183
    v_lshl_add_u32 v183, v183, 2, v112
    v_subb_co_u32 v184, vcc, v184, v107, s[64:65]
    v_add_u32 v113, s42, v184
    v_min_u32 v184, v184, v113
    v_addc_co_u32 v184, vcc, 0, v184, s[64:65]
    v_min_u32 v184, v114, v184
    v_lshl_add_u32 v184, v184, 2, v112
    v_subb_co_u32 v185, vcc, v185, v107, s[66:67]
    v_add_u32 v113, s42, v185
    v_min_u32 v185, v185, v113
    v_addc_co_u32 v185, vcc, 0, v185, s[66:67]
    v_min_u32 v185, v114, v185
    v_lshl_add_u32 v185, v185, 2, v112
afm_tab_kernel_hskip:
    v_mov_b32 v16, 161536
afm_tab_kernel_pollP:
    ds_read2st64_b32 v[18:19], v16 offset0:0 offset1:1
    ds_read2st64_b32 v[20:21], v16 offset0:2 offset1:3
    s_waitcnt lgkmcnt(0)
    v_readfirstlane_b32 s64, v18
    v_readfirstlane_b32 s65, v19
    v_readfirstlane_b32 s66, v20
    v_readfirstlane_b32 s67, v21
    s_xor_b32 s64, s64, 149504
    s_xor_b32 s65, s65, 151552
    s_xor_b32 s66, s66, 153600
    s_xor_b32 s67, s67, 155648
    s_or_b32 s64, s64, s65
    s_or_b32 s66, s66, s67
    s_or_b32 s64, s64, s66
    s_cmp_eq_u32 s64, 0
    s_cbranch_scc1 afm_tab_kernel_gotP
    s_sleep 2
    s_branch afm_tab_kernel_pollP
afm_tab_kernel_gotP:
    v_mov_b32 v12, 130896
afm_tab_kernel_pollL2:
    ds_read_b128 v[16:19], v12 offset:0
    s_waitcnt lgkmcnt(0)
    v_add3_u32 v16, v16, v17, v18
    v_add_u32 v16, v16, v19
    s_nop 0
    v_readfirstlane_b32 s46, v16
    s_cmp_eq_u32 s46, 4
    s_cbranch_scc1 afm_tab_kernel_pollL2_ok
    s_sleep 2
    s_branch afm_tab_kernel_pollL2
afm_tab_kernel_pollL2_ok:
    s_lshl_b32 s46, s50, 11
    s_add_u32 s46, s46, 147712
    v_add_u32 v4, s46, v89
    s_lshl_b32 s46, s50, 12
    s_add_u32 s46, s46, 131072
    v_lshl_add_u32 v5, v89, 1, s46
    ds_read_b128 v[24:27], v4 offset:0
    ds_read_b128 v[28:31], v5 offset:0
    ds_read_b128 v[32:35], v5 offset:16
    ds_read_b128 v[36:39], v4 offset:1024
    ds_read_b128 v[40:43], v5 offset:2048
    ds_read_b128 v[44:47], v5 offset:2064
    s_cmp_lg_u32 s49, 1
    s_cbranch_scc1 afm_tab_kernel_noho
    s_mul_i32 s46, s50, 7168
    v_add_u32 v6, s46, v89
    v_cndmask_b32 v186, -1, v105, s[82:83]
    v_mov_b32 v187, 0
    ds_write_b128 v6, v[160:163] offset:0
    ds_write_b128 v6, v[164:167] offset:1024
    ds_write_b128 v6, v[168:171] offset:2048
    ds_write_b128 v6, v[172:175] offset:3072
    ds_write_b128 v6, v[176:179] offset:4096
    ds_write_b128 v6, v[180:183] offset:5120
    ds_write_b128 v6, v[184:187] offset:6144
afm_tab_kernel_noho:
    s_mov_b32 s46, 0x3f38aa3b
    s_waitcnt lgkmcnt(0)
    v_fma_f32 v24, v24, s46, v28
    v_fma_f32 v25, v25, s46, v30
    v_fma_f32 v26, v26, s46, v32
    v_fma_f32 v27, v27, s46, v34
    v_cvt_pk_bf16_f32 v24, v29, v24
    v_cvt_pk_bf16_f32 v25, v31, v25
    v_cvt_pk_bf16_f32 v26, v33, v26
    v_cvt_pk_bf16_f32 v27, v35, v27
    v_fma_f32 v36, v36, s46, v40
    v_fma_f32 v37, v37, s46, v42
    v_fma_f32 v38, v38, s46, v44
    v_fma_f32 v39, v39, s46, v46
    v_cvt_pk_bf16_f32 v36, v41, v36
    v_cvt_pk_bf16_f32 v37, v43, v37
    v_cvt_pk_bf16_f32 v38, v45, v38
    v_cvt_pk_bf16_f32 v39, v47, v39
    ds_write_b128 v4, v[24:27]
    s_mov_b32 exec_hi, 0xffff
    ds_write_b128 v4, v[36:39] offset:1024
    s_mov_b32 exec_hi, -1
afm_tab_kernel_fin:
    s_setprio 0
    s_waitcnt lgkmcnt(0)
    s_barrier
    s_mov_b32 s44, 0x3f800000
    s_cmp_ge_u32 s3, 4
    s_cbranch_scc1 afm_tab_kernel_hl
    s_mul_i32 s46, s3, 7168
    v_lshlrev_b32 v4, 4, v0
    v_add_u32 v4, s46, v4
    v_mov_b32 v5, 130848
    ds_read_b32 v6, v5
    ds_read_b128 v[128:131], v4 offset:0
    ds_read_b128 v[132:135], v4 offset:1024
    ds_read_b128 v[136:139], v4 offset:2048
    ds_read_b128 v[140:143], v4 offset:3072
    ds_read_b128 v[144:147], v4 offset:4096
    ds_read_b128 v[148:151], v4 offset:5120
    ds_read_b128 v[152:155], v4 offset:6144
    s_mov_b32 s36, s6
    s_mov_b32 s37, s7
    s_mov_b32 s38, 0x10000000
    s_mov_b32 s39, 0x00020000
    s_mov_b32 s45, 0xf149f2ca
    s_waitcnt lgkmcnt(0)
    v_readfirstlane_b32 s49, v6
    s_cmp_lg_u32 s49, 1
    s_cbranch_scc1 afm_tab_kernel_end
    ds_read_b32 v128, v128
    ds_read_b32 v129, v129
    ds_read_b32 v130, v130
    ds_read_b32 v131, v131
    ds_read_b32 v132, v132
    ds_read_b32 v133, v133
    ds_read_b32 v134, v134
    ds_read_b32 v135, v135
    ds_read_b32 v136, v136
    ds_read_b32 v137, v137
    ds_read_b32 v138, v138
    ds_read_b32 v139, v139
    ds_read_b32 v140, v140
    ds_read_b32 v141, v141
    ds_read_b32 v142, v142
    v_cmp_ne_u32 s[54:55], -1, v154
    v_lshlrev_b32 v16, 4, v154
    s_waitcnt lgkmcnt(4)
    ds_read_b32 v143, v143
    ds_read_b32 v144, v144
    ds_read_b32 v145, v145
    ds_read_b32 v146, v146
    ds_read_b32 v147, v147
    ds_read_b32 v148, v148
    ds_read_b32 v149, v149
    ds_read_b32 v150, v150
    ds_read_b32 v151, v151
    ds_read_b32 v152, v152
    ds_read_b32 v153, v153
    s_waitcnt lgkmcnt(0)
    v_max3_f32 v188, v128, v129, s45
    v_max3_f32 v188, v188, v130, v131
    v_max3_f32 v188, v188, v132, v133
    v_max3_f32 v188, v188, v134, v135
    v_max3_f32 v188, v188, v136, v137
    v_max3_f32 v188, v188, v138, v139
    v_max3_f32 v188, v188, v140, v141
    v_max3_f32 v188, v188, v142, v143
    v_max3_f32 v188, v188, v144, v145
    v_max3_f32 v188, v188, v146, v147
    v_max3_f32 v188, v188, v148, v149
    v_max3_f32 v188, v188, v150, v151
    v_max3_f32 v188, v188, v152, v153
    v_and_b32 v188, 0xffff0000, v188
    v_xor_b32 v191, 0x80000000, v188
    s_nop 1
    v_dot2_f32_bf16 v160, v128, s44, v191
    v_dot2_f32_bf16 v161, v129, s44, v191
    v_dot2_f32_bf16 v162, v130, s44, v191
    v_dot2_f32_bf16 v163, v131, s44, v191
    v_dot2_f32_bf16 v164, v132, s44, v191
    v_dot2_f32_bf16 v165, v133, s44, v191
    v_dot2_f32_bf16 v166, v134, s44, v191
    v_dot2_f32_bf16 v167, v135, s44, v191
    v_dot2_f32_bf16 v168, v136, s44, v191
    v_dot2_f32_bf16 v169, v137, s44, v191
    v_dot2_f32_bf16 v170, v138, s44, v191
    v_dot2_f32_bf16 v171, v139, s44, v191
    v_dot2_f32_bf16 v172, v140, s44, v191
    v_dot2_f32_bf16 v173, v141, s44, v191
    v_dot2_f32_bf16 v174, v142, s44, v191
    v_dot2_f32_bf16 v175, v143, s44, v191
    v_dot2_f32_bf16 v176, v144, s44, v191
    v_dot2_f32_bf16 v177, v145, s44, v191
    v_dot2_f32_bf16 v178, v146, s44, v191
    v_dot2_f32_bf16 v179, v147, s44, v191
    v_dot2_f32_bf16 v180, v148, s44, v191
    v_dot2_f32_bf16 v181, v149, s44, v191
    v_dot2_f32_bf16 v182, v150, s44, v191
    v_dot2_f32_bf16 v183, v151, s44, v191
    v_dot2_f32_bf16 v184, v152, s44, v191
    v_dot2_f32_bf16 v185, v153, s44, v191
    s_nop 2
    v_exp_f32 v160, v160
    v_lshlrev_b32 v128, 16, v128
    v_exp_f32 v161, v161
    v_lshlrev_b32 v129, 16, v129
    v_exp_f32 v162, v162
    v_lshlrev_b32 v130, 16, v130
    v_exp_f32 v163, v163
    v_lshlrev_b32 v131, 16, v131
    v_exp_f32 v164, v164
    v_lshlrev_b32 v132, 16, v132
    v_exp_f32 v165, v165
    v_lshlrev_b32 v133, 16, v133
    v_exp_f32 v166, v166
    v_lshlrev_b32 v134, 16, v134
    v_exp_f32 v167, v167
    v_lshlrev_b32 v135, 16, v135
    v_exp_f32 v168, v168
    v_lshlrev_b32 v136, 16, v136
    v_exp_f32 v169, v169
    v_lshlrev_b32 v137, 16, v137
    v_exp_f32 v170, v170
    v_lshlrev_b32 v138, 16, v138
    v_exp_f32 v171, v171
    v_lshlrev_b32 v139, 16, v139
    v_exp_f32 v172, v172
    v_lshlrev_b32 v140, 16, v140
    v_exp_f32 v173, v173
    v_lshlrev_b32 v141, 16, v141
    v_exp_f32 v174, v174
    v_lshlrev_b32 v142, 16, v142
    v_exp_f32 v175, v175
    v_lshlrev_b32 v143, 16, v143
    v_exp_f32 v176, v176
    v_lshlrev_b32 v144, 16, v144
    v_exp_f32 v177, v177
    v_lshlrev_b32 v145, 16, v145
    v_exp_f32 v178, v178
    v_lshlrev_b32 v146, 16, v146
    v_exp_f32 v179, v179
    v_lshlrev_b32 v147, 16, v147
    v_exp_f32 v180, v180
    v_lshlrev_b32 v148, 16, v148
    v_exp_f32 v181, v181
    v_lshlrev_b32 v149, 16, v149
    v_exp_f32 v182, v182
    v_lshlrev_b32 v150, 16, v150
    v_exp_f32 v183, v183
    v_lshlrev_b32 v151, 16, v151
    v_exp_f32 v184, v184
    v_lshlrev_b32 v152, 16, v152
    v_exp_f32 v185, v185
    v_lshlrev_b32 v153, 16, v153
    v_pk_add_f32 v[192:193], v[160:161], v[162:163]
    v_pk_mul_f32 v[194:195], v[160:161], v[128:129]
    v_pk_fma_f32 v[194:195], v[162:163], v[130:131], v[194:195]
    v_pk_add_f32 v[192:193], v[192:193], v[164:165]
    v_pk_fma_f32 v[194:195], v[164:165], v[132:133], v[194:195]
    v_pk_add_f32 v[192:193], v[192:193], v[166:167]
    v_pk_fma_f32 v[194:195], v[166:167], v[134:135], v[194:195]
    v_pk_add_f32 v[192:193], v[192:193], v[168:169]
    v_pk_fma_f32 v[194:195], v[168:169], v[136:137], v[194:195]
    v_pk_add_f32 v[192:193], v[192:193], v[170:171]
    v_pk_fma_f32 v[194:195], v[170:171], v[138:139], v[194:195]
    v_pk_add_f32 v[192:193], v[192:193], v[172:173]
    v_pk_fma_f32 v[194:195], v[172:173], v[140:141], v[194:195]
    v_pk_add_f32 v[192:193], v[192:193], v[174:175]
    v_pk_fma_f32 v[194:195], v[174:175], v[142:143], v[194:195]
    v_pk_add_f32 v[192:193], v[192:193], v[176:177]
    v_pk_fma_f32 v[194:195], v[176:177], v[144:145], v[194:195]
    v_pk_add_f32 v[192:193], v[192:193], v[178:179]
    v_pk_fma_f32 v[194:195], v[178:179], v[146:147], v[194:195]
    v_pk_add_f32 v[192:193], v[192:193], v[180:181]
    v_pk_fma_f32 v[194:195], v[180:181], v[148:149], v[194:195]
    v_pk_add_f32 v[192:193], v[192:193], v[182:183]
    v_pk_fma_f32 v[194:195], v[182:183], v[150:151], v[194:195]
    v_pk_add_f32 v[192:193], v[192:193], v[184:185]
    v_pk_fma_f32 v[194:195], v[184:185], v[152:153], v[194:195]
    v_add_f32 v189, v192, v193
    v_add_f32 v190, v194, v195
    v_mov_b32 v191, 0
    s_mov_b64 exec, s[54:55]
    buffer_store_dwordx4 v[188:191], v16, s[36:39], 0 offen sc1
    s_mov_b64 exec, -1
    s_branch afm_tab_kernel_end
afm_tab_kernel_hl:
    s_cmp_lg_u32 s49, 1
    s_cbranch_scc1 afm_tab_kernel_slow
    ds_read_b32 v128, v128
    ds_read_b32 v129, v129
    ds_read_b32 v130, v130
    ds_read_b32 v131, v131
    ds_read_b32 v132, v132
    ds_read_b32 v133, v133
    ds_read_b32 v134, v134
    ds_read_b32 v135, v135
    ds_read_b32 v136, v136
    ds_read_b32 v137, v137
    ds_read_b32 v138, v138
    ds_read_b32 v139, v139
    ds_read_b32 v140, v140
    ds_read_b32 v141, v141
    ds_read_b32 v142, v142
    v_lshlrev_b32 v16, 4, v104
    s_waitcnt lgkmcnt(4)
    ds_read_b32 v143, v143
    ds_read_b32 v144, v144
    ds_read_b32 v145, v145
    ds_read_b32 v146, v146
    ds_read_b32 v147, v147
    ds_read_b32 v148, v148
    ds_read_b32 v149, v149
    ds_read_b32 v150, v150
    ds_read_b32 v151, v151
    ds_read_b32 v152, v152
    ds_read_b32 v153, v153
    s_waitcnt lgkmcnt(0)
    v_max3_f32 v224, v128, v129, s45
    v_max3_f32 v224, v224, v130, v131
    v_max3_f32 v224, v224, v132, v133
    v_max3_f32 v224, v224, v134, v135
    v_max3_f32 v224, v224, v136, v137
    v_max3_f32 v224, v224, v138, v139
    v_max3_f32 v224, v224, v140, v141
    v_max3_f32 v224, v224, v142, v143
    v_max3_f32 v224, v224, v144, v145
    v_max3_f32 v224, v224, v146, v147
    v_max3_f32 v224, v224, v148, v149
    v_max3_f32 v224, v224, v150, v151
    v_max3_f32 v224, v224, v152, v153
    v_and_b32 v224, 0xffff0000, v224
    v_xor_b32 v227, 0x80000000, v224
    s_nop 1
    v_dot2_f32_bf16 v192, v128, s44, v227
    v_dot2_f32_bf16 v193, v129, s44, v227
    v_dot2_f32_bf16 v194, v130, s44, v227
    v_dot2_f32_bf16 v195, v131, s44, v227
    v_dot2_f32_bf16 v196, v132, s44, v227
    v_dot2_f32_bf16 v197, v133, s44, v227
    v_dot2_f32_bf16 v198, v134, s44, v227
    v_dot2_f32_bf16 v199, v135, s44, v227
    v_dot2_f32_bf16 v200, v136, s44, v227
    v_dot2_f32_bf16 v201, v137, s44, v227
    v_dot2_f32_bf16 v202, v138, s44, v227
    v_dot2_f32_bf16 v203, v139, s44, v227
    v_dot2_f32_bf16 v204, v140, s44, v227
    v_dot2_f32_bf16 v205, v141, s44, v227
    v_dot2_f32_bf16 v206, v142, s44, v227
    v_dot2_f32_bf16 v207, v143, s44, v227
    v_dot2_f32_bf16 v208, v144, s44, v227
    v_dot2_f32_bf16 v209, v145, s44, v227
    v_dot2_f32_bf16 v210, v146, s44, v227
    v_dot2_f32_bf16 v211, v147, s44, v227
    v_dot2_f32_bf16 v212, v148, s44, v227
    v_dot2_f32_bf16 v213, v149, s44, v227
    v_dot2_f32_bf16 v214, v150, s44, v227
    v_dot2_f32_bf16 v215, v151, s44, v227
    v_dot2_f32_bf16 v216, v152, s44, v227
    v_dot2_f32_bf16 v217, v153, s44, v227
    s_nop 2
    v_exp_f32 v192, v192
    v_lshlrev_b32 v128, 16, v128
    v_exp_f32 v193, v193
    v_lshlrev_b32 v129, 16, v129
    v_exp_f32 v194, v194
    v_lshlrev_b32 v130, 16, v130
    v_exp_f32 v195, v195
    v_lshlrev_b32 v131, 16, v131
    v_exp_f32 v196, v196
    v_lshlrev_b32 v132, 16, v132
    v_exp_f32 v197, v197
    v_lshlrev_b32 v133, 16, v133
    v_exp_f32 v198, v198
    v_lshlrev_b32 v134, 16, v134
    v_exp_f32 v199, v199
    v_lshlrev_b32 v135, 16, v135
    v_exp_f32 v200, v200
    v_lshlrev_b32 v136, 16, v136
    v_exp_f32 v201, v201
    v_lshlrev_b32 v137, 16, v137
    v_exp_f32 v202, v202
    v_lshlrev_b32 v138, 16, v138
    v_exp_f32 v203, v203
    v_lshlrev_b32 v139, 16, v139
    v_exp_f32 v204, v204
    v_lshlrev_b32 v140, 16, v140
    v_exp_f32 v205, v205
    v_lshlrev_b32 v141, 16, v141
    v_exp_f32 v206, v206
    v_lshlrev_b32 v142, 16, v142
    v_exp_f32 v207, v207
    v_lshlrev_b32 v143, 16, v143
    v_exp_f32 v208, v208
    v_lshlrev_b32 v144, 16, v144
    v_exp_f32 v209, v209
    v_lshlrev_b32 v145, 16, v145
    v_exp_f32 v210, v210
    v_lshlrev_b32 v146, 16, v146
    v_exp_f32 v211, v211
    v_lshlrev_b32 v147, 16, v147
    v_exp_f32 v212, v212
    v_lshlrev_b32 v148, 16, v148
    v_exp_f32 v213, v213
    v_lshlrev_b32 v149, 16, v149
    v_exp_f32 v214, v214
    v_lshlrev_b32 v150, 16, v150
    v_exp_f32 v215, v215
    v_lshlrev_b32 v151, 16, v151
    v_exp_f32 v216, v216
    v_lshlrev_b32 v152, 16, v152
    v_exp_f32 v217, v217
    v_lshlrev_b32 v153, 16, v153
    v_pk_add_f32 v[228:229], v[192:193], v[194:195]
    v_pk_mul_f32 v[230:231], v[192:193], v[128:129]
    v_pk_fma_f32 v[230:231], v[194:195], v[130:131], v[230:231]
    v_pk_add_f32 v[228:229], v[228:229], v[196:197]
    v_pk_fma_f32 v[230:231], v[196:197], v[132:133], v[230:231]
    v_pk_add_f32 v[228:229], v[228:229], v[198:199]
    v_pk_fma_f32 v[230:231], v[198:199], v[134:135], v[230:231]
    v_pk_add_f32 v[228:229], v[228:229], v[200:201]
    v_pk_fma_f32 v[230:231], v[200:201], v[136:137], v[230:231]
    v_pk_add_f32 v[228:229], v[228:229], v[202:203]
    v_pk_fma_f32 v[230:231], v[202:203], v[138:139], v[230:231]
    v_pk_add_f32 v[228:229], v[228:229], v[204:205]
    v_pk_fma_f32 v[230:231], v[204:205], v[140:141], v[230:231]
    v_pk_add_f32 v[228:229], v[228:229], v[206:207]
    v_pk_fma_f32 v[230:231], v[206:207], v[142:143], v[230:231]
    v_pk_add_f32 v[228:229], v[228:229], v[208:209]
    v_pk_fma_f32 v[230:231], v[208:209], v[144:145], v[230:231]
    v_pk_add_f32 v[228:229], v[228:229], v[210:211]
    v_pk_fma_f32 v[230:231], v[210:211], v[146:147], v[230:231]
    v_pk_add_f32 v[228:229], v[228:229], v[212:213]
    v_pk_fma_f32 v[230:231], v[212:213], v[148:149], v[230:231]
    v_pk_add_f32 v[228:229], v[228:229], v[214:215]
    v_pk_fma_f32 v[230:231], v[214:215], v[150:151], v[230:231]
    v_pk_add_f32 v[228:229], v[228:229], v[216:217]
    v_pk_fma_f32 v[230:231], v[216:217], v[152:153], v[230:231]
    v_add_f32 v225, v228, v229
    v_add_f32 v226, v230, v231
    v_mov_b32 v227, 0
    s_mov_b64 exec, s[54:55]
    buffer_store_dwordx4 v[224:227], v16, s[36:39], 0 offen sc1
    s_mov_b64 exec, -1
    s_branch afm_tab_kernel_end
afm_tab_kernel_slow:
    s_mul_i32 s60, s50, 106496
    s_mul_i32 s62, s50, 26624
    s_mov_b32 s51, 0
afm_tab_kernel_sl_g:
    buffer_load_dwordx4 v[232:235], v89, s[56:59], s60 offen
    s_waitcnt vmcnt(0)
    v_xor_b32 v16, s40, v232
    v_cmp_gt_u32 vcc, 4, v16
    s_cbranch_vccz afm_tab_kernel_sl_k0
    s_and_saveexec_b64 s[80:81], vcc
    s_add_u32 s46, s62, 0
    v_add_u32 v104, s46, v91
    v_mul_hi_u32 v112, v104, s41
    v_lshlrev_b32 v114, 2, v104
    v_mul_u32_u24 v113, 26, v112
    v_mul_u32_u24 v112, 104, v112
    v_sub_u32 v108, v104, v113
    buffer_load_dword v106, v114, s[56:59], 0 offen
    buffer_load_dwordx4 v[128:131], v112, s[56:59], 0 offen offset:0
    buffer_load_dwordx4 v[132:135], v112, s[56:59], 0 offen offset:16
    buffer_load_dwordx4 v[136:139], v112, s[56:59], 0 offen offset:32
    buffer_load_dwordx4 v[140:143], v112, s[56:59], 0 offen offset:48
    buffer_load_dwordx4 v[144:147], v112, s[56:59], 0 offen offset:64
    buffer_load_dwordx4 v[148:151], v112, s[56:59], 0 offen offset:80
    buffer_load_dwordx2 v[152:153], v112, s[56:59], 0 offen offset:96
    s_waitcnt vmcnt(0)
    v_and_b32 v112, 3, v106
    v_sub_u32 v114, s43, v112
    v_mul_u32_u24 v112, 2052, v112
    v_add_u32 v112, 147712, v112
    v_cmp_le_u32 s[64:65], 0, v108
    v_cmp_le_u32 s[66:67], 1, v108
    v_cmp_le_u32 s[68:69], 2, v108
    v_subb_co_u32 v128, vcc, v128, v106, s[64:65]
    v_add_u32 v113, s42, v128
    v_min_u32 v128, v128, v113
    v_addc_co_u32 v128, vcc, 0, v128, s[64:65]
    v_min_u32 v128, v114, v128
    v_lshl_add_u32 v128, v128, 2, v112
    v_cmp_le_u32 s[70:71], 3, v108
    v_subb_co_u32 v129, vcc, v129, v106, s[66:67]
    v_add_u32 v113, s42, v129
    v_min_u32 v129, v129, v113
    v_addc_co_u32 v129, vcc, 0, v129, s[66:67]
    v_min_u32 v129, v114, v129
    v_lshl_add_u32 v129, v129, 2, v112
    v_cmp_le_u32 s[64:65], 4, v108
    v_subb_co_u32 v130, vcc, v130, v106, s[68:69]
    v_add_u32 v113, s42, v130
    v_min_u32 v130, v130, v113
    v_addc_co_u32 v130, vcc, 0, v130, s[68:69]
    v_min_u32 v130, v114, v130
    v_lshl_add_u32 v130, v130, 2, v112
    v_cmp_le_u32 s[66:67], 5, v108
    v_subb_co_u32 v131, vcc, v131, v106, s[70:71]
    v_add_u32 v113, s42, v131
    v_min_u32 v131, v131, v113
    v_addc_co_u32 v131, vcc, 0, v131, s[70:71]
    v_min_u32 v131, v114, v131
    v_lshl_add_u32 v131, v131, 2, v112
    v_cmp_le_u32 s[68:69], 6, v108
    v_subb_co_u32 v132, vcc, v132, v106, s[64:65]
    v_add_u32 v113, s42, v132
    v_min_u32 v132, v132, v113
    v_addc_co_u32 v132, vcc, 0, v132, s[64:65]
    v_min_u32 v132, v114, v132
    v_lshl_add_u32 v132, v132, 2, v112
    v_cmp_le_u32 s[70:71], 7, v108
    v_subb_co_u32 v133, vcc, v133, v106, s[66:67]
    v_add_u32 v113, s42, v133
    v_min_u32 v133, v133, v113
    v_addc_co_u32 v133, vcc, 0, v133, s[66:67]
    v_min_u32 v133, v114, v133
    v_lshl_add_u32 v133, v133, 2, v112
    v_cmp_le_u32 s[64:65], 8, v108
    v_subb_co_u32 v134, vcc, v134, v106, s[68:69]
    v_add_u32 v113, s42, v134
    v_min_u32 v134, v134, v113
    v_addc_co_u32 v134, vcc, 0, v134, s[68:69]
    v_min_u32 v134, v114, v134
    v_lshl_add_u32 v134, v134, 2, v112
    v_cmp_le_u32 s[66:67], 9, v108
    v_subb_co_u32 v135, vcc, v135, v106, s[70:71]
    v_add_u32 v113, s42, v135
    v_min_u32 v135, v135, v113
    v_addc_co_u32 v135, vcc, 0, v135, s[70:71]
    v_min_u32 v135, v114, v135
    v_lshl_add_u32 v135, v135, 2, v112
    v_cmp_le_u32 s[68:69], 10, v108
    v_subb_co_u32 v136, vcc, v136, v106, s[64:65]
    v_add_u32 v113, s42, v136
    v_min_u32 v136, v136, v113
    v_addc_co_u32 v136, vcc, 0, v136, s[64:65]
    v_min_u32 v136, v114, v136
    v_lshl_add_u32 v136, v136, 2, v112
    v_cmp_le_u32 s[70:71], 11, v108
    v_subb_co_u32 v137, vcc, v137, v106, s[66:67]
    v_add_u32 v113, s42, v137
    v_min_u32 v137, v137, v113
    v_addc_co_u32 v137, vcc, 0, v137, s[66:67]
    v_min_u32 v137, v114, v137
    v_lshl_add_u32 v137, v137, 2, v112
    v_cmp_le_u32 s[64:65], 12, v108
    v_subb_co_u32 v138, vcc, v138, v106, s[68:69]
    v_add_u32 v113, s42, v138
    v_min_u32 v138, v138, v113
    v_addc_co_u32 v138, vcc, 0, v138, s[68:69]
    v_min_u32 v138, v114, v138
    v_lshl_add_u32 v138, v138, 2, v112
    v_cmp_le_u32 s[66:67], 13, v108
    v_subb_co_u32 v139, vcc, v139, v106, s[70:71]
    v_add_u32 v113, s42, v139
    v_min_u32 v139, v139, v113
    v_addc_co_u32 v139, vcc, 0, v139, s[70:71]
    v_min_u32 v139, v114, v139
    v_lshl_add_u32 v139, v139, 2, v112
    v_cmp_le_u32 s[68:69], 14, v108
    v_subb_co_u32 v140, vcc, v140, v106, s[64:65]
    v_add_u32 v113, s42, v140
    v_min_u32 v140, v140, v113
    v_addc_co_u32 v140, vcc, 0, v140, s[64:65]
    v_min_u32 v140, v114, v140
    v_lshl_add_u32 v140, v140, 2, v112
    v_cmp_le_u32 s[70:71], 15, v108
    v_subb_co_u32 v141, vcc, v141, v106, s[66:67]
    v_add_u32 v113, s42, v141
    v_min_u32 v141, v141, v113
    v_addc_co_u32 v141, vcc, 0, v141, s[66:67]
    v_min_u32 v141, v114, v141
    v_lshl_add_u32 v141, v141, 2, v112
    v_cmp_le_u32 s[64:65], 16, v108
    v_subb_co_u32 v142, vcc, v142, v106, s[68:69]
    v_add_u32 v113, s42, v142
    v_min_u32 v142, v142, v113
    v_addc_co_u32 v142, vcc, 0, v142, s[68:69]
    v_min_u32 v142, v114, v142
    v_lshl_add_u32 v142, v142, 2, v112
    v_cmp_le_u32 s[66:67], 17, v108
    v_subb_co_u32 v143, vcc, v143, v106, s[70:71]
    v_add_u32 v113, s42, v143
    v_min_u32 v143, v143, v113
    v_addc_co_u32 v143, vcc, 0, v143, s[70:71]
    v_min_u32 v143, v114, v143
    v_lshl_add_u32 v143, v143, 2, v112
    v_cmp_le_u32 s[68:69], 18, v108
    v_subb_co_u32 v144, vcc, v144, v106, s[64:65]
    v_add_u32 v113, s42, v144
    v_min_u32 v144, v144, v113
    v_addc_co_u32 v144, vcc, 0, v144, s[64:65]
    v_min_u32 v144, v114, v144
    v_lshl_add_u32 v144, v144, 2, v112
    v_cmp_le_u32 s[70:71], 19, v108
    v_subb_co_u32 v145, vcc, v145, v106, s[66:67]
    v_add_u32 v113, s42, v145
    v_min_u32 v145, v145, v113
    v_addc_co_u32 v145, vcc, 0, v145, s[66:67]
    v_min_u32 v145, v114, v145
    v_lshl_add_u32 v145, v145, 2, v112
    v_cmp_le_u32 s[64:65], 20, v108
    v_subb_co_u32 v146, vcc, v146, v106, s[68:69]
    v_add_u32 v113, s42, v146
    v_min_u32 v146, v146, v113
    v_addc_co_u32 v146, vcc, 0, v146, s[68:69]
    v_min_u32 v146, v114, v146
    v_lshl_add_u32 v146, v146, 2, v112
    v_cmp_le_u32 s[66:67], 21, v108
    v_subb_co_u32 v147, vcc, v147, v106, s[70:71]
    v_add_u32 v113, s42, v147
    v_min_u32 v147, v147, v113
    v_addc_co_u32 v147, vcc, 0, v147, s[70:71]
    v_min_u32 v147, v114, v147
    v_lshl_add_u32 v147, v147, 2, v112
    v_cmp_le_u32 s[68:69], 22, v108
    v_subb_co_u32 v148, vcc, v148, v106, s[64:65]
    v_add_u32 v113, s42, v148
    v_min_u32 v148, v148, v113
    v_addc_co_u32 v148, vcc, 0, v148, s[64:65]
    v_min_u32 v148, v114, v148
    v_lshl_add_u32 v148, v148, 2, v112
    v_cmp_le_u32 s[70:71], 23, v108
    v_subb_co_u32 v149, vcc, v149, v106, s[66:67]
    v_add_u32 v113, s42, v149
    v_min_u32 v149, v149, v113
    v_addc_co_u32 v149, vcc, 0, v149, s[66:67]
    v_min_u32 v149, v114, v149
    v_lshl_add_u32 v149, v149, 2, v112
    v_cmp_le_u32 s[64:65], 24, v108
    v_subb_co_u32 v150, vcc, v150, v106, s[68:69]
    v_add_u32 v113, s42, v150
    v_min_u32 v150, v150, v113
    v_addc_co_u32 v150, vcc, 0, v150, s[68:69]
    v_min_u32 v150, v114, v150
    v_lshl_add_u32 v150, v150, 2, v112
    v_cmp_le_u32 s[66:67], 25, v108
    v_subb_co_u32 v151, vcc, v151, v106, s[70:71]
    v_add_u32 v113, s42, v151
    v_min_u32 v151, v151, v113
    v_addc_co_u32 v151, vcc, 0, v151, s[70:71]
    v_min_u32 v151, v114, v151
    v_lshl_add_u32 v151, v151, 2, v112
    v_subb_co_u32 v152, vcc, v152, v106, s[64:65]
    v_add_u32 v113, s42, v152
    v_min_u32 v152, v152, v113
    v_addc_co_u32 v152, vcc, 0, v152, s[64:65]
    v_min_u32 v152, v114, v152
    v_lshl_add_u32 v152, v152, 2, v112
    v_subb_co_u32 v153, vcc, v153, v106, s[66:67]
    v_add_u32 v113, s42, v153
    v_min_u32 v153, v153, v113
    v_addc_co_u32 v153, vcc, 0, v153, s[66:67]
    v_min_u32 v153, v114, v153
    v_lshl_add_u32 v153, v153, 2, v112
    ds_read_b32 v128, v128
    ds_read_b32 v129, v129
    ds_read_b32 v130, v130
    ds_read_b32 v131, v131
    ds_read_b32 v132, v132
    ds_read_b32 v133, v133
    ds_read_b32 v134, v134
    ds_read_b32 v135, v135
    ds_read_b32 v136, v136
    ds_read_b32 v137, v137
    ds_read_b32 v138, v138
    ds_read_b32 v139, v139
    ds_read_b32 v140, v140
    ds_read_b32 v141, v141
    ds_read_b32 v142, v142
    s_waitcnt lgkmcnt(4)
    ds_read_b32 v143, v143
    ds_read_b32 v144, v144
    ds_read_b32 v145, v145
    ds_read_b32 v146, v146
    ds_read_b32 v147, v147
    ds_read_b32 v148, v148
    ds_read_b32 v149, v149
    ds_read_b32 v150, v150
    ds_read_b32 v151, v151
    ds_read_b32 v152, v152
    ds_read_b32 v153, v153
    s_waitcnt lgkmcnt(0)
    v_max3_f32 v224, v128, v129, s45
    v_max3_f32 v224, v224, v130, v131
    v_max3_f32 v224, v224, v132, v133
    v_max3_f32 v224, v224, v134, v135
    v_max3_f32 v224, v224, v136, v137
    v_max3_f32 v224, v224, v138, v139
    v_max3_f32 v224, v224, v140, v141
    v_max3_f32 v224, v224, v142, v143
    v_max3_f32 v224, v224, v144, v145
    v_max3_f32 v224, v224, v146, v147
    v_max3_f32 v224, v224, v148, v149
    v_max3_f32 v224, v224, v150, v151
    v_max3_f32 v224, v224, v152, v153
    v_and_b32 v224, 0xffff0000, v224
    v_xor_b32 v227, 0x80000000, v224
    s_nop 1
    v_dot2_f32_bf16 v192, v128, s44, v227
    v_dot2_f32_bf16 v193, v129, s44, v227
    v_dot2_f32_bf16 v194, v130, s44, v227
    v_dot2_f32_bf16 v195, v131, s44, v227
    v_dot2_f32_bf16 v196, v132, s44, v227
    v_dot2_f32_bf16 v197, v133, s44, v227
    v_dot2_f32_bf16 v198, v134, s44, v227
    v_dot2_f32_bf16 v199, v135, s44, v227
    v_dot2_f32_bf16 v200, v136, s44, v227
    v_dot2_f32_bf16 v201, v137, s44, v227
    v_dot2_f32_bf16 v202, v138, s44, v227
    v_dot2_f32_bf16 v203, v139, s44, v227
    v_dot2_f32_bf16 v204, v140, s44, v227
    v_dot2_f32_bf16 v205, v141, s44, v227
    v_dot2_f32_bf16 v206, v142, s44, v227
    v_dot2_f32_bf16 v207, v143, s44, v227
    v_dot2_f32_bf16 v208, v144, s44, v227
    v_dot2_f32_bf16 v209, v145, s44, v227
    v_dot2_f32_bf16 v210, v146, s44, v227
    v_dot2_f32_bf16 v211, v147, s44, v227
    v_dot2_f32_bf16 v212, v148, s44, v227
    v_dot2_f32_bf16 v213, v149, s44, v227
    v_dot2_f32_bf16 v214, v150, s44, v227
    v_dot2_f32_bf16 v215, v151, s44, v227
    v_dot2_f32_bf16 v216, v152, s44, v227
    v_dot2_f32_bf16 v217, v153, s44, v227
    s_nop 2
    v_exp_f32 v192, v192
    v_lshlrev_b32 v128, 16, v128
    v_exp_f32 v193, v193
    v_lshlrev_b32 v129, 16, v129
    v_exp_f32 v194, v194
    v_lshlrev_b32 v130, 16, v130
    v_exp_f32 v195, v195
    v_lshlrev_b32 v131, 16, v131
    v_exp_f32 v196, v196
    v_lshlrev_b32 v132, 16, v132
    v_exp_f32 v197, v197
    v_lshlrev_b32 v133, 16, v133
    v_exp_f32 v198, v198
    v_lshlrev_b32 v134, 16, v134
    v_exp_f32 v199, v199
    v_lshlrev_b32 v135, 16, v135
    v_exp_f32 v200, v200
    v_lshlrev_b32 v136, 16, v136
    v_exp_f32 v201, v201
    v_lshlrev_b32 v137, 16, v137
    v_exp_f32 v202, v202
    v_lshlrev_b32 v138, 16, v138
    v_exp_f32 v203, v203
    v_lshlrev_b32 v139, 16, v139
    v_exp_f32 v204, v204
    v_lshlrev_b32 v140, 16, v140
    v_exp_f32 v205, v205
    v_lshlrev_b32 v141, 16, v141
    v_exp_f32 v206, v206
    v_lshlrev_b32 v142, 16, v142
    v_exp_f32 v207, v207
    v_lshlrev_b32 v143, 16, v143
    v_exp_f32 v208, v208
    v_lshlrev_b32 v144, 16, v144
    v_exp_f32 v209, v209
    v_lshlrev_b32 v145, 16, v145
    v_exp_f32 v210, v210
    v_lshlrev_b32 v146, 16, v146
    v_exp_f32 v211, v211
    v_lshlrev_b32 v147, 16, v147
    v_exp_f32 v212, v212
    v_lshlrev_b32 v148, 16, v148
    v_exp_f32 v213, v213
    v_lshlrev_b32 v149, 16, v149
    v_exp_f32 v214, v214
    v_lshlrev_b32 v150, 16, v150
    v_exp_f32 v215, v215
    v_lshlrev_b32 v151, 16, v151
    v_exp_f32 v216, v216
    v_lshlrev_b32 v152, 16, v152
    v_exp_f32 v217, v217
    v_lshlrev_b32 v153, 16, v153
    v_pk_add_f32 v[228:229], v[192:193], v[194:195]
    v_pk_mul_f32 v[230:231], v[192:193], v[128:129]
    v_pk_fma_f32 v[230:231], v[194:195], v[130:131], v[230:231]
    v_pk_add_f32 v[228:229], v[228:229], v[196:197]
    v_pk_fma_f32 v[230:231], v[196:197], v[132:133], v[230:231]
    v_pk_add_f32 v[228:229], v[228:229], v[198:199]
    v_pk_fma_f32 v[230:231], v[198:199], v[134:135], v[230:231]
    v_pk_add_f32 v[228:229], v[228:229], v[200:201]
    v_pk_fma_f32 v[230:231], v[200:201], v[136:137], v[230:231]
    v_pk_add_f32 v[228:229], v[228:229], v[202:203]
    v_pk_fma_f32 v[230:231], v[202:203], v[138:139], v[230:231]
    v_pk_add_f32 v[228:229], v[228:229], v[204:205]
    v_pk_fma_f32 v[230:231], v[204:205], v[140:141], v[230:231]
    v_pk_add_f32 v[228:229], v[228:229], v[206:207]
    v_pk_fma_f32 v[230:231], v[206:207], v[142:143], v[230:231]
    v_pk_add_f32 v[228:229], v[228:229], v[208:209]
    v_pk_fma_f32 v[230:231], v[208:209], v[144:145], v[230:231]
    v_pk_add_f32 v[228:229], v[228:229], v[210:211]
    v_pk_fma_f32 v[230:231], v[210:211], v[146:147], v[230:231]
    v_pk_add_f32 v[228:229], v[228:229], v[212:213]
    v_pk_fma_f32 v[230:231], v[212:213], v[148:149], v[230:231]
    v_pk_add_f32 v[228:229], v[228:229], v[214:215]
    v_pk_fma_f32 v[230:231], v[214:215], v[150:151], v[230:231]
    v_pk_add_f32 v[228:229], v[228:229], v[216:217]
    v_pk_fma_f32 v[230:231], v[216:217], v[152:153], v[230:231]
    v_add_f32 v225, v228, v229
    v_add_f32 v226, v230, v231
    v_mov_b32 v227, 0
    v_lshlrev_b32 v16, 4, v104
    buffer_store_dwordx4 v[224:227], v16, s[36:39], 0 offen sc1
    s_mov_b64 exec, s[80:81]
afm_tab_kernel_sl_k0:
    v_xor_b32 v16, s40, v233
    v_cmp_gt_u32 vcc, 4, v16
    s_cbranch_vccz afm_tab_kernel_sl_k1
    s_and_saveexec_b64 s[80:81], vcc
    s_add_u32 s46, s62, 1
    v_add_u32 v104, s46, v91
    v_mul_hi_u32 v112, v104, s41
    v_lshlrev_b32 v114, 2, v104
    v_mul_u32_u24 v113, 26, v112
    v_mul_u32_u24 v112, 104, v112
    v_sub_u32 v108, v104, v113
    buffer_load_dword v106, v114, s[56:59], 0 offen
    buffer_load_dwordx4 v[128:131], v112, s[56:59], 0 offen offset:0
    buffer_load_dwordx4 v[132:135], v112, s[56:59], 0 offen offset:16
    buffer_load_dwordx4 v[136:139], v112, s[56:59], 0 offen offset:32
    buffer_load_dwordx4 v[140:143], v112, s[56:59], 0 offen offset:48
    buffer_load_dwordx4 v[144:147], v112, s[56:59], 0 offen offset:64
    buffer_load_dwordx4 v[148:151], v112, s[56:59], 0 offen offset:80
    buffer_load_dwordx2 v[152:153], v112, s[56:59], 0 offen offset:96
    s_waitcnt vmcnt(0)
    v_and_b32 v112, 3, v106
    v_sub_u32 v114, s43, v112
    v_mul_u32_u24 v112, 2052, v112
    v_add_u32 v112, 147712, v112
    v_cmp_le_u32 s[64:65], 0, v108
    v_cmp_le_u32 s[66:67], 1, v108
    v_cmp_le_u32 s[68:69], 2, v108
    v_subb_co_u32 v128, vcc, v128, v106, s[64:65]
    v_add_u32 v113, s42, v128
    v_min_u32 v128, v128, v113
    v_addc_co_u32 v128, vcc, 0, v128, s[64:65]
    v_min_u32 v128, v114, v128
    v_lshl_add_u32 v128, v128, 2, v112
    v_cmp_le_u32 s[70:71], 3, v108
    v_subb_co_u32 v129, vcc, v129, v106, s[66:67]
    v_add_u32 v113, s42, v129
    v_min_u32 v129, v129, v113
    v_addc_co_u32 v129, vcc, 0, v129, s[66:67]
    v_min_u32 v129, v114, v129
    v_lshl_add_u32 v129, v129, 2, v112
    v_cmp_le_u32 s[64:65], 4, v108
    v_subb_co_u32 v130, vcc, v130, v106, s[68:69]
    v_add_u32 v113, s42, v130
    v_min_u32 v130, v130, v113
    v_addc_co_u32 v130, vcc, 0, v130, s[68:69]
    v_min_u32 v130, v114, v130
    v_lshl_add_u32 v130, v130, 2, v112
    v_cmp_le_u32 s[66:67], 5, v108
    v_subb_co_u32 v131, vcc, v131, v106, s[70:71]
    v_add_u32 v113, s42, v131
    v_min_u32 v131, v131, v113
    v_addc_co_u32 v131, vcc, 0, v131, s[70:71]
    v_min_u32 v131, v114, v131
    v_lshl_add_u32 v131, v131, 2, v112
    v_cmp_le_u32 s[68:69], 6, v108
    v_subb_co_u32 v132, vcc, v132, v106, s[64:65]
    v_add_u32 v113, s42, v132
    v_min_u32 v132, v132, v113
    v_addc_co_u32 v132, vcc, 0, v132, s[64:65]
    v_min_u32 v132, v114, v132
    v_lshl_add_u32 v132, v132, 2, v112
    v_cmp_le_u32 s[70:71], 7, v108
    v_subb_co_u32 v133, vcc, v133, v106, s[66:67]
    v_add_u32 v113, s42, v133
    v_min_u32 v133, v133, v113
    v_addc_co_u32 v133, vcc, 0, v133, s[66:67]
    v_min_u32 v133, v114, v133
    v_lshl_add_u32 v133, v133, 2, v112
    v_cmp_le_u32 s[64:65], 8, v108
    v_subb_co_u32 v134, vcc, v134, v106, s[68:69]
    v_add_u32 v113, s42, v134
    v_min_u32 v134, v134, v113
    v_addc_co_u32 v134, vcc, 0, v134, s[68:69]
    v_min_u32 v134, v114, v134
    v_lshl_add_u32 v134, v134, 2, v112
    v_cmp_le_u32 s[66:67], 9, v108
    v_subb_co_u32 v135, vcc, v135, v106, s[70:71]
    v_add_u32 v113, s42, v135
    v_min_u32 v135, v135, v113
    v_addc_co_u32 v135, vcc, 0, v135, s[70:71]
    v_min_u32 v135, v114, v135
    v_lshl_add_u32 v135, v135, 2, v112
    v_cmp_le_u32 s[68:69], 10, v108
    v_subb_co_u32 v136, vcc, v136, v106, s[64:65]
    v_add_u32 v113, s42, v136
    v_min_u32 v136, v136, v113
    v_addc_co_u32 v136, vcc, 0, v136, s[64:65]
    v_min_u32 v136, v114, v136
    v_lshl_add_u32 v136, v136, 2, v112
    v_cmp_le_u32 s[70:71], 11, v108
    v_subb_co_u32 v137, vcc, v137, v106, s[66:67]
    v_add_u32 v113, s42, v137
    v_min_u32 v137, v137, v113
    v_addc_co_u32 v137, vcc, 0, v137, s[66:67]
    v_min_u32 v137, v114, v137
    v_lshl_add_u32 v137, v137, 2, v112
    v_cmp_le_u32 s[64:65], 12, v108
    v_subb_co_u32 v138, vcc, v138, v106, s[68:69]
    v_add_u32 v113, s42, v138
    v_min_u32 v138, v138, v113
    v_addc_co_u32 v138, vcc, 0, v138, s[68:69]
    v_min_u32 v138, v114, v138
    v_lshl_add_u32 v138, v138, 2, v112
    v_cmp_le_u32 s[66:67], 13, v108
    v_subb_co_u32 v139, vcc, v139, v106, s[70:71]
    v_add_u32 v113, s42, v139
    v_min_u32 v139, v139, v113
    v_addc_co_u32 v139, vcc, 0, v139, s[70:71]
    v_min_u32 v139, v114, v139
    v_lshl_add_u32 v139, v139, 2, v112
    v_cmp_le_u32 s[68:69], 14, v108
    v_subb_co_u32 v140, vcc, v140, v106, s[64:65]
    v_add_u32 v113, s42, v140
    v_min_u32 v140, v140, v113
    v_addc_co_u32 v140, vcc, 0, v140, s[64:65]
    v_min_u32 v140, v114, v140
    v_lshl_add_u32 v140, v140, 2, v112
    v_cmp_le_u32 s[70:71], 15, v108
    v_subb_co_u32 v141, vcc, v141, v106, s[66:67]
    v_add_u32 v113, s42, v141
    v_min_u32 v141, v141, v113
    v_addc_co_u32 v141, vcc, 0, v141, s[66:67]
    v_min_u32 v141, v114, v141
    v_lshl_add_u32 v141, v141, 2, v112
    v_cmp_le_u32 s[64:65], 16, v108
    v_subb_co_u32 v142, vcc, v142, v106, s[68:69]
    v_add_u32 v113, s42, v142
    v_min_u32 v142, v142, v113
    v_addc_co_u32 v142, vcc, 0, v142, s[68:69]
    v_min_u32 v142, v114, v142
    v_lshl_add_u32 v142, v142, 2, v112
    v_cmp_le_u32 s[66:67], 17, v108
    v_subb_co_u32 v143, vcc, v143, v106, s[70:71]
    v_add_u32 v113, s42, v143
    v_min_u32 v143, v143, v113
    v_addc_co_u32 v143, vcc, 0, v143, s[70:71]
    v_min_u32 v143, v114, v143
    v_lshl_add_u32 v143, v143, 2, v112
    v_cmp_le_u32 s[68:69], 18, v108
    v_subb_co_u32 v144, vcc, v144, v106, s[64:65]
    v_add_u32 v113, s42, v144
    v_min_u32 v144, v144, v113
    v_addc_co_u32 v144, vcc, 0, v144, s[64:65]
    v_min_u32 v144, v114, v144
    v_lshl_add_u32 v144, v144, 2, v112
    v_cmp_le_u32 s[70:71], 19, v108
    v_subb_co_u32 v145, vcc, v145, v106, s[66:67]
    v_add_u32 v113, s42, v145
    v_min_u32 v145, v145, v113
    v_addc_co_u32 v145, vcc, 0, v145, s[66:67]
    v_min_u32 v145, v114, v145
    v_lshl_add_u32 v145, v145, 2, v112
    v_cmp_le_u32 s[64:65], 20, v108
    v_subb_co_u32 v146, vcc, v146, v106, s[68:69]
    v_add_u32 v113, s42, v146
    v_min_u32 v146, v146, v113
    v_addc_co_u32 v146, vcc, 0, v146, s[68:69]
    v_min_u32 v146, v114, v146
    v_lshl_add_u32 v146, v146, 2, v112
    v_cmp_le_u32 s[66:67], 21, v108
    v_subb_co_u32 v147, vcc, v147, v106, s[70:71]
    v_add_u32 v113, s42, v147
    v_min_u32 v147, v147, v113
    v_addc_co_u32 v147, vcc, 0, v147, s[70:71]
    v_min_u32 v147, v114, v147
    v_lshl_add_u32 v147, v147, 2, v112
    v_cmp_le_u32 s[68:69], 22, v108
    v_subb_co_u32 v148, vcc, v148, v106, s[64:65]
    v_add_u32 v113, s42, v148
    v_min_u32 v148, v148, v113
    v_addc_co_u32 v148, vcc, 0, v148, s[64:65]
    v_min_u32 v148, v114, v148
    v_lshl_add_u32 v148, v148, 2, v112
    v_cmp_le_u32 s[70:71], 23, v108
    v_subb_co_u32 v149, vcc, v149, v106, s[66:67]
    v_add_u32 v113, s42, v149
    v_min_u32 v149, v149, v113
    v_addc_co_u32 v149, vcc, 0, v149, s[66:67]
    v_min_u32 v149, v114, v149
    v_lshl_add_u32 v149, v149, 2, v112
    v_cmp_le_u32 s[64:65], 24, v108
    v_subb_co_u32 v150, vcc, v150, v106, s[68:69]
    v_add_u32 v113, s42, v150
    v_min_u32 v150, v150, v113
    v_addc_co_u32 v150, vcc, 0, v150, s[68:69]
    v_min_u32 v150, v114, v150
    v_lshl_add_u32 v150, v150, 2, v112
    v_cmp_le_u32 s[66:67], 25, v108
    v_subb_co_u32 v151, vcc, v151, v106, s[70:71]
    v_add_u32 v113, s42, v151
    v_min_u32 v151, v151, v113
    v_addc_co_u32 v151, vcc, 0, v151, s[70:71]
    v_min_u32 v151, v114, v151
    v_lshl_add_u32 v151, v151, 2, v112
    v_subb_co_u32 v152, vcc, v152, v106, s[64:65]
    v_add_u32 v113, s42, v152
    v_min_u32 v152, v152, v113
    v_addc_co_u32 v152, vcc, 0, v152, s[64:65]
    v_min_u32 v152, v114, v152
    v_lshl_add_u32 v152, v152, 2, v112
    v_subb_co_u32 v153, vcc, v153, v106, s[66:67]
    v_add_u32 v113, s42, v153
    v_min_u32 v153, v153, v113
    v_addc_co_u32 v153, vcc, 0, v153, s[66:67]
    v_min_u32 v153, v114, v153
    v_lshl_add_u32 v153, v153, 2, v112
    ds_read_b32 v128, v128
    ds_read_b32 v129, v129
    ds_read_b32 v130, v130
    ds_read_b32 v131, v131
    ds_read_b32 v132, v132
    ds_read_b32 v133, v133
    ds_read_b32 v134, v134
    ds_read_b32 v135, v135
    ds_read_b32 v136, v136
    ds_read_b32 v137, v137
    ds_read_b32 v138, v138
    ds_read_b32 v139, v139
    ds_read_b32 v140, v140
    ds_read_b32 v141, v141
    ds_read_b32 v142, v142
    s_waitcnt lgkmcnt(4)
    ds_read_b32 v143, v143
    ds_read_b32 v144, v144
    ds_read_b32 v145, v145
    ds_read_b32 v146, v146
    ds_read_b32 v147, v147
    ds_read_b32 v148, v148
    ds_read_b32 v149, v149
    ds_read_b32 v150, v150
    ds_read_b32 v151, v151
    ds_read_b32 v152, v152
    ds_read_b32 v153, v153
    s_waitcnt lgkmcnt(0)
    v_max3_f32 v224, v128, v129, s45
    v_max3_f32 v224, v224, v130, v131
    v_max3_f32 v224, v224, v132, v133
    v_max3_f32 v224, v224, v134, v135
    v_max3_f32 v224, v224, v136, v137
    v_max3_f32 v224, v224, v138, v139
    v_max3_f32 v224, v224, v140, v141
    v_max3_f32 v224, v224, v142, v143
    v_max3_f32 v224, v224, v144, v145
    v_max3_f32 v224, v224, v146, v147
    v_max3_f32 v224, v224, v148, v149
    v_max3_f32 v224, v224, v150, v151
    v_max3_f32 v224, v224, v152, v153
    v_and_b32 v224, 0xffff0000, v224
    v_xor_b32 v227, 0x80000000, v224
    s_nop 1
    v_dot2_f32_bf16 v192, v128, s44, v227
    v_dot2_f32_bf16 v193, v129, s44, v227
    v_dot2_f32_bf16 v194, v130, s44, v227
    v_dot2_f32_bf16 v195, v131, s44, v227
    v_dot2_f32_bf16 v196, v132, s44, v227
    v_dot2_f32_bf16 v197, v133, s44, v227
    v_dot2_f32_bf16 v198, v134, s44, v227
    v_dot2_f32_bf16 v199, v135, s44, v227
    v_dot2_f32_bf16 v200, v136, s44, v227
    v_dot2_f32_bf16 v201, v137, s44, v227
    v_dot2_f32_bf16 v202, v138, s44, v227
    v_dot2_f32_bf16 v203, v139, s44, v227
    v_dot2_f32_bf16 v204, v140, s44, v227
    v_dot2_f32_bf16 v205, v141, s44, v227
    v_dot2_f32_bf16 v206, v142, s44, v227
    v_dot2_f32_bf16 v207, v143, s44, v227
    v_dot2_f32_bf16 v208, v144, s44, v227
    v_dot2_f32_bf16 v209, v145, s44, v227
    v_dot2_f32_bf16 v210, v146, s44, v227
    v_dot2_f32_bf16 v211, v147, s44, v227
    v_dot2_f32_bf16 v212, v148, s44, v227
    v_dot2_f32_bf16 v213, v149, s44, v227
    v_dot2_f32_bf16 v214, v150, s44, v227
    v_dot2_f32_bf16 v215, v151, s44, v227
    v_dot2_f32_bf16 v216, v152, s44, v227
    v_dot2_f32_bf16 v217, v153, s44, v227
    s_nop 2
    v_exp_f32 v192, v192
    v_lshlrev_b32 v128, 16, v128
    v_exp_f32 v193, v193
    v_lshlrev_b32 v129, 16, v129
    v_exp_f32 v194, v194
    v_lshlrev_b32 v130, 16, v130
    v_exp_f32 v195, v195
    v_lshlrev_b32 v131, 16, v131
    v_exp_f32 v196, v196
    v_lshlrev_b32 v132, 16, v132
    v_exp_f32 v197, v197
    v_lshlrev_b32 v133, 16, v133
    v_exp_f32 v198, v198
    v_lshlrev_b32 v134, 16, v134
    v_exp_f32 v199, v199
    v_lshlrev_b32 v135, 16, v135
    v_exp_f32 v200, v200
    v_lshlrev_b32 v136, 16, v136
    v_exp_f32 v201, v201
    v_lshlrev_b32 v137, 16, v137
    v_exp_f32 v202, v202
    v_lshlrev_b32 v138, 16, v138
    v_exp_f32 v203, v203
    v_lshlrev_b32 v139, 16, v139
    v_exp_f32 v204, v204
    v_lshlrev_b32 v140, 16, v140
    v_exp_f32 v205, v205
    v_lshlrev_b32 v141, 16, v141
    v_exp_f32 v206, v206
    v_lshlrev_b32 v142, 16, v142
    v_exp_f32 v207, v207
    v_lshlrev_b32 v143, 16, v143
    v_exp_f32 v208, v208
    v_lshlrev_b32 v144, 16, v144
    v_exp_f32 v209, v209
    v_lshlrev_b32 v145, 16, v145
    v_exp_f32 v210, v210
    v_lshlrev_b32 v146, 16, v146
    v_exp_f32 v211, v211
    v_lshlrev_b32 v147, 16, v147
    v_exp_f32 v212, v212
    v_lshlrev_b32 v148, 16, v148
    v_exp_f32 v213, v213
    v_lshlrev_b32 v149, 16, v149
    v_exp_f32 v214, v214
    v_lshlrev_b32 v150, 16, v150
    v_exp_f32 v215, v215
    v_lshlrev_b32 v151, 16, v151
    v_exp_f32 v216, v216
    v_lshlrev_b32 v152, 16, v152
    v_exp_f32 v217, v217
    v_lshlrev_b32 v153, 16, v153
    v_pk_add_f32 v[228:229], v[192:193], v[194:195]
    v_pk_mul_f32 v[230:231], v[192:193], v[128:129]
    v_pk_fma_f32 v[230:231], v[194:195], v[130:131], v[230:231]
    v_pk_add_f32 v[228:229], v[228:229], v[196:197]
    v_pk_fma_f32 v[230:231], v[196:197], v[132:133], v[230:231]
    v_pk_add_f32 v[228:229], v[228:229], v[198:199]
    v_pk_fma_f32 v[230:231], v[198:199], v[134:135], v[230:231]
    v_pk_add_f32 v[228:229], v[228:229], v[200:201]
    v_pk_fma_f32 v[230:231], v[200:201], v[136:137], v[230:231]
    v_pk_add_f32 v[228:229], v[228:229], v[202:203]
    v_pk_fma_f32 v[230:231], v[202:203], v[138:139], v[230:231]
    v_pk_add_f32 v[228:229], v[228:229], v[204:205]
    v_pk_fma_f32 v[230:231], v[204:205], v[140:141], v[230:231]
    v_pk_add_f32 v[228:229], v[228:229], v[206:207]
    v_pk_fma_f32 v[230:231], v[206:207], v[142:143], v[230:231]
    v_pk_add_f32 v[228:229], v[228:229], v[208:209]
    v_pk_fma_f32 v[230:231], v[208:209], v[144:145], v[230:231]
    v_pk_add_f32 v[228:229], v[228:229], v[210:211]
    v_pk_fma_f32 v[230:231], v[210:211], v[146:147], v[230:231]
    v_pk_add_f32 v[228:229], v[228:229], v[212:213]
    v_pk_fma_f32 v[230:231], v[212:213], v[148:149], v[230:231]
    v_pk_add_f32 v[228:229], v[228:229], v[214:215]
    v_pk_fma_f32 v[230:231], v[214:215], v[150:151], v[230:231]
    v_pk_add_f32 v[228:229], v[228:229], v[216:217]
    v_pk_fma_f32 v[230:231], v[216:217], v[152:153], v[230:231]
    v_add_f32 v225, v228, v229
    v_add_f32 v226, v230, v231
    v_mov_b32 v227, 0
    v_lshlrev_b32 v16, 4, v104
    buffer_store_dwordx4 v[224:227], v16, s[36:39], 0 offen sc1
    s_mov_b64 exec, s[80:81]
afm_tab_kernel_sl_k1:
    v_xor_b32 v16, s40, v234
    v_cmp_gt_u32 vcc, 4, v16
    s_cbranch_vccz afm_tab_kernel_sl_k2
    s_and_saveexec_b64 s[80:81], vcc
    s_add_u32 s46, s62, 2
    v_add_u32 v104, s46, v91
    v_mul_hi_u32 v112, v104, s41
    v_lshlrev_b32 v114, 2, v104
    v_mul_u32_u24 v113, 26, v112
    v_mul_u32_u24 v112, 104, v112
    v_sub_u32 v108, v104, v113
    buffer_load_dword v106, v114, s[56:59], 0 offen
    buffer_load_dwordx4 v[128:131], v112, s[56:59], 0 offen offset:0
    buffer_load_dwordx4 v[132:135], v112, s[56:59], 0 offen offset:16
    buffer_load_dwordx4 v[136:139], v112, s[56:59], 0 offen offset:32
    buffer_load_dwordx4 v[140:143], v112, s[56:59], 0 offen offset:48
    buffer_load_dwordx4 v[144:147], v112, s[56:59], 0 offen offset:64
    buffer_load_dwordx4 v[148:151], v112, s[56:59], 0 offen offset:80
    buffer_load_dwordx2 v[152:153], v112, s[56:59], 0 offen offset:96
    s_waitcnt vmcnt(0)
    v_and_b32 v112, 3, v106
    v_sub_u32 v114, s43, v112
    v_mul_u32_u24 v112, 2052, v112
    v_add_u32 v112, 147712, v112
    v_cmp_le_u32 s[64:65], 0, v108
    v_cmp_le_u32 s[66:67], 1, v108
    v_cmp_le_u32 s[68:69], 2, v108
    v_subb_co_u32 v128, vcc, v128, v106, s[64:65]
    v_add_u32 v113, s42, v128
    v_min_u32 v128, v128, v113
    v_addc_co_u32 v128, vcc, 0, v128, s[64:65]
    v_min_u32 v128, v114, v128
    v_lshl_add_u32 v128, v128, 2, v112
    v_cmp_le_u32 s[70:71], 3, v108
    v_subb_co_u32 v129, vcc, v129, v106, s[66:67]
    v_add_u32 v113, s42, v129
    v_min_u32 v129, v129, v113
    v_addc_co_u32 v129, vcc, 0, v129, s[66:67]
    v_min_u32 v129, v114, v129
    v_lshl_add_u32 v129, v129, 2, v112
    v_cmp_le_u32 s[64:65], 4, v108
    v_subb_co_u32 v130, vcc, v130, v106, s[68:69]
    v_add_u32 v113, s42, v130
    v_min_u32 v130, v130, v113
    v_addc_co_u32 v130, vcc, 0, v130, s[68:69]
    v_min_u32 v130, v114, v130
    v_lshl_add_u32 v130, v130, 2, v112
    v_cmp_le_u32 s[66:67], 5, v108
    v_subb_co_u32 v131, vcc, v131, v106, s[70:71]
    v_add_u32 v113, s42, v131
    v_min_u32 v131, v131, v113
    v_addc_co_u32 v131, vcc, 0, v131, s[70:71]
    v_min_u32 v131, v114, v131
    v_lshl_add_u32 v131, v131, 2, v112
    v_cmp_le_u32 s[68:69], 6, v108
    v_subb_co_u32 v132, vcc, v132, v106, s[64:65]
    v_add_u32 v113, s42, v132
    v_min_u32 v132, v132, v113
    v_addc_co_u32 v132, vcc, 0, v132, s[64:65]
    v_min_u32 v132, v114, v132
    v_lshl_add_u32 v132, v132, 2, v112
    v_cmp_le_u32 s[70:71], 7, v108
    v_subb_co_u32 v133, vcc, v133, v106, s[66:67]
    v_add_u32 v113, s42, v133
    v_min_u32 v133, v133, v113
    v_addc_co_u32 v133, vcc, 0, v133, s[66:67]
    v_min_u32 v133, v114, v133
    v_lshl_add_u32 v133, v133, 2, v112
    v_cmp_le_u32 s[64:65], 8, v108
    v_subb_co_u32 v134, vcc, v134, v106, s[68:69]
    v_add_u32 v113, s42, v134
    v_min_u32 v134, v134, v113
    v_addc_co_u32 v134, vcc, 0, v134, s[68:69]
    v_min_u32 v134, v114, v134
    v_lshl_add_u32 v134, v134, 2, v112
    v_cmp_le_u32 s[66:67], 9, v108
    v_subb_co_u32 v135, vcc, v135, v106, s[70:71]
    v_add_u32 v113, s42, v135
    v_min_u32 v135, v135, v113
    v_addc_co_u32 v135, vcc, 0, v135, s[70:71]
    v_min_u32 v135, v114, v135
    v_lshl_add_u32 v135, v135, 2, v112
    v_cmp_le_u32 s[68:69], 10, v108
    v_subb_co_u32 v136, vcc, v136, v106, s[64:65]
    v_add_u32 v113, s42, v136
    v_min_u32 v136, v136, v113
    v_addc_co_u32 v136, vcc, 0, v136, s[64:65]
    v_min_u32 v136, v114, v136
    v_lshl_add_u32 v136, v136, 2, v112
    v_cmp_le_u32 s[70:71], 11, v108
    v_subb_co_u32 v137, vcc, v137, v106, s[66:67]
    v_add_u32 v113, s42, v137
    v_min_u32 v137, v137, v113
    v_addc_co_u32 v137, vcc, 0, v137, s[66:67]
    v_min_u32 v137, v114, v137
    v_lshl_add_u32 v137, v137, 2, v112
    v_cmp_le_u32 s[64:65], 12, v108
    v_subb_co_u32 v138, vcc, v138, v106, s[68:69]
    v_add_u32 v113, s42, v138
    v_min_u32 v138, v138, v113
    v_addc_co_u32 v138, vcc, 0, v138, s[68:69]
    v_min_u32 v138, v114, v138
    v_lshl_add_u32 v138, v138, 2, v112
    v_cmp_le_u32 s[66:67], 13, v108
    v_subb_co_u32 v139, vcc, v139, v106, s[70:71]
    v_add_u32 v113, s42, v139
    v_min_u32 v139, v139, v113
    v_addc_co_u32 v139, vcc, 0, v139, s[70:71]
    v_min_u32 v139, v114, v139
    v_lshl_add_u32 v139, v139, 2, v112
    v_cmp_le_u32 s[68:69], 14, v108
    v_subb_co_u32 v140, vcc, v140, v106, s[64:65]
    v_add_u32 v113, s42, v140
    v_min_u32 v140, v140, v113
    v_addc_co_u32 v140, vcc, 0, v140, s[64:65]
    v_min_u32 v140, v114, v140
    v_lshl_add_u32 v140, v140, 2, v112
    v_cmp_le_u32 s[70:71], 15, v108
    v_subb_co_u32 v141, vcc, v141, v106, s[66:67]
    v_add_u32 v113, s42, v141
    v_min_u32 v141, v141, v113
    v_addc_co_u32 v141, vcc, 0, v141, s[66:67]
    v_min_u32 v141, v114, v141
    v_lshl_add_u32 v141, v141, 2, v112
    v_cmp_le_u32 s[64:65], 16, v108
    v_subb_co_u32 v142, vcc, v142, v106, s[68:69]
    v_add_u32 v113, s42, v142
    v_min_u32 v142, v142, v113
    v_addc_co_u32 v142, vcc, 0, v142, s[68:69]
    v_min_u32 v142, v114, v142
    v_lshl_add_u32 v142, v142, 2, v112
    v_cmp_le_u32 s[66:67], 17, v108
    v_subb_co_u32 v143, vcc, v143, v106, s[70:71]
    v_add_u32 v113, s42, v143
    v_min_u32 v143, v143, v113
    v_addc_co_u32 v143, vcc, 0, v143, s[70:71]
    v_min_u32 v143, v114, v143
    v_lshl_add_u32 v143, v143, 2, v112
    v_cmp_le_u32 s[68:69], 18, v108
    v_subb_co_u32 v144, vcc, v144, v106, s[64:65]
    v_add_u32 v113, s42, v144
    v_min_u32 v144, v144, v113
    v_addc_co_u32 v144, vcc, 0, v144, s[64:65]
    v_min_u32 v144, v114, v144
    v_lshl_add_u32 v144, v144, 2, v112
    v_cmp_le_u32 s[70:71], 19, v108
    v_subb_co_u32 v145, vcc, v145, v106, s[66:67]
    v_add_u32 v113, s42, v145
    v_min_u32 v145, v145, v113
    v_addc_co_u32 v145, vcc, 0, v145, s[66:67]
    v_min_u32 v145, v114, v145
    v_lshl_add_u32 v145, v145, 2, v112
    v_cmp_le_u32 s[64:65], 20, v108
    v_subb_co_u32 v146, vcc, v146, v106, s[68:69]
    v_add_u32 v113, s42, v146
    v_min_u32 v146, v146, v113
    v_addc_co_u32 v146, vcc, 0, v146, s[68:69]
    v_min_u32 v146, v114, v146
    v_lshl_add_u32 v146, v146, 2, v112
    v_cmp_le_u32 s[66:67], 21, v108
    v_subb_co_u32 v147, vcc, v147, v106, s[70:71]
    v_add_u32 v113, s42, v147
    v_min_u32 v147, v147, v113
    v_addc_co_u32 v147, vcc, 0, v147, s[70:71]
    v_min_u32 v147, v114, v147
    v_lshl_add_u32 v147, v147, 2, v112
    v_cmp_le_u32 s[68:69], 22, v108
    v_subb_co_u32 v148, vcc, v148, v106, s[64:65]
    v_add_u32 v113, s42, v148
    v_min_u32 v148, v148, v113
    v_addc_co_u32 v148, vcc, 0, v148, s[64:65]
    v_min_u32 v148, v114, v148
    v_lshl_add_u32 v148, v148, 2, v112
    v_cmp_le_u32 s[70:71], 23, v108
    v_subb_co_u32 v149, vcc, v149, v106, s[66:67]
    v_add_u32 v113, s42, v149
    v_min_u32 v149, v149, v113
    v_addc_co_u32 v149, vcc, 0, v149, s[66:67]
    v_min_u32 v149, v114, v149
    v_lshl_add_u32 v149, v149, 2, v112
    v_cmp_le_u32 s[64:65], 24, v108
    v_subb_co_u32 v150, vcc, v150, v106, s[68:69]
    v_add_u32 v113, s42, v150
    v_min_u32 v150, v150, v113
    v_addc_co_u32 v150, vcc, 0, v150, s[68:69]
    v_min_u32 v150, v114, v150
    v_lshl_add_u32 v150, v150, 2, v112
    v_cmp_le_u32 s[66:67], 25, v108
    v_subb_co_u32 v151, vcc, v151, v106, s[70:71]
    v_add_u32 v113, s42, v151
    v_min_u32 v151, v151, v113
    v_addc_co_u32 v151, vcc, 0, v151, s[70:71]
    v_min_u32 v151, v114, v151
    v_lshl_add_u32 v151, v151, 2, v112
    v_subb_co_u32 v152, vcc, v152, v106, s[64:65]
    v_add_u32 v113, s42, v152
    v_min_u32 v152, v152, v113
    v_addc_co_u32 v152, vcc, 0, v152, s[64:65]
    v_min_u32 v152, v114, v152
    v_lshl_add_u32 v152, v152, 2, v112
    v_subb_co_u32 v153, vcc, v153, v106, s[66:67]
    v_add_u32 v113, s42, v153
    v_min_u32 v153, v153, v113
    v_addc_co_u32 v153, vcc, 0, v153, s[66:67]
    v_min_u32 v153, v114, v153
    v_lshl_add_u32 v153, v153, 2, v112
    ds_read_b32 v128, v128
    ds_read_b32 v129, v129
    ds_read_b32 v130, v130
    ds_read_b32 v131, v131
    ds_read_b32 v132, v132
    ds_read_b32 v133, v133
    ds_read_b32 v134, v134
    ds_read_b32 v135, v135
    ds_read_b32 v136, v136
    ds_read_b32 v137, v137
    ds_read_b32 v138, v138
    ds_read_b32 v139, v139
    ds_read_b32 v140, v140
    ds_read_b32 v141, v141
    ds_read_b32 v142, v142
    s_waitcnt lgkmcnt(4)
    ds_read_b32 v143, v143
    ds_read_b32 v144, v144
    ds_read_b32 v145, v145
    ds_read_b32 v146, v146
    ds_read_b32 v147, v147
    ds_read_b32 v148, v148
    ds_read_b32 v149, v149
    ds_read_b32 v150, v150
    ds_read_b32 v151, v151
    ds_read_b32 v152, v152
    ds_read_b32 v153, v153
    s_waitcnt lgkmcnt(0)
    v_max3_f32 v224, v128, v129, s45
    v_max3_f32 v224, v224, v130, v131
    v_max3_f32 v224, v224, v132, v133
    v_max3_f32 v224, v224, v134, v135
    v_max3_f32 v224, v224, v136, v137
    v_max3_f32 v224, v224, v138, v139
    v_max3_f32 v224, v224, v140, v141
    v_max3_f32 v224, v224, v142, v143
    v_max3_f32 v224, v224, v144, v145
    v_max3_f32 v224, v224, v146, v147
    v_max3_f32 v224, v224, v148, v149
    v_max3_f32 v224, v224, v150, v151
    v_max3_f32 v224, v224, v152, v153
    v_and_b32 v224, 0xffff0000, v224
    v_xor_b32 v227, 0x80000000, v224
    s_nop 1
    v_dot2_f32_bf16 v192, v128, s44, v227
    v_dot2_f32_bf16 v193, v129, s44, v227
    v_dot2_f32_bf16 v194, v130, s44, v227
    v_dot2_f32_bf16 v195, v131, s44, v227
    v_dot2_f32_bf16 v196, v132, s44, v227
    v_dot2_f32_bf16 v197, v133, s44, v227
    v_dot2_f32_bf16 v198, v134, s44, v227
    v_dot2_f32_bf16 v199, v135, s44, v227
    v_dot2_f32_bf16 v200, v136, s44, v227
    v_dot2_f32_bf16 v201, v137, s44, v227
    v_dot2_f32_bf16 v202, v138, s44, v227
    v_dot2_f32_bf16 v203, v139, s44, v227
    v_dot2_f32_bf16 v204, v140, s44, v227
    v_dot2_f32_bf16 v205, v141, s44, v227
    v_dot2_f32_bf16 v206, v142, s44, v227
    v_dot2_f32_bf16 v207, v143, s44, v227
    v_dot2_f32_bf16 v208, v144, s44, v227
    v_dot2_f32_bf16 v209, v145, s44, v227
    v_dot2_f32_bf16 v210, v146, s44, v227
    v_dot2_f32_bf16 v211, v147, s44, v227
    v_dot2_f32_bf16 v212, v148, s44, v227
    v_dot2_f32_bf16 v213, v149, s44, v227
    v_dot2_f32_bf16 v214, v150, s44, v227
    v_dot2_f32_bf16 v215, v151, s44, v227
    v_dot2_f32_bf16 v216, v152, s44, v227
    v_dot2_f32_bf16 v217, v153, s44, v227
    s_nop 2
    v_exp_f32 v192, v192
    v_lshlrev_b32 v128, 16, v128
    v_exp_f32 v193, v193
    v_lshlrev_b32 v129, 16, v129
    v_exp_f32 v194, v194
    v_lshlrev_b32 v130, 16, v130
    v_exp_f32 v195, v195
    v_lshlrev_b32 v131, 16, v131
    v_exp_f32 v196, v196
    v_lshlrev_b32 v132, 16, v132
    v_exp_f32 v197, v197
    v_lshlrev_b32 v133, 16, v133
    v_exp_f32 v198, v198
    v_lshlrev_b32 v134, 16, v134
    v_exp_f32 v199, v199
    v_lshlrev_b32 v135, 16, v135
    v_exp_f32 v200, v200
    v_lshlrev_b32 v136, 16, v136
    v_exp_f32 v201, v201
    v_lshlrev_b32 v137, 16, v137
    v_exp_f32 v202, v202
    v_lshlrev_b32 v138, 16, v138
    v_exp_f32 v203, v203
    v_lshlrev_b32 v139, 16, v139
    v_exp_f32 v204, v204
    v_lshlrev_b32 v140, 16, v140
    v_exp_f32 v205, v205
    v_lshlrev_b32 v141, 16, v141
    v_exp_f32 v206, v206
    v_lshlrev_b32 v142, 16, v142
    v_exp_f32 v207, v207
    v_lshlrev_b32 v143, 16, v143
    v_exp_f32 v208, v208
    v_lshlrev_b32 v144, 16, v144
    v_exp_f32 v209, v209
    v_lshlrev_b32 v145, 16, v145
    v_exp_f32 v210, v210
    v_lshlrev_b32 v146, 16, v146
    v_exp_f32 v211, v211
    v_lshlrev_b32 v147, 16, v147
    v_exp_f32 v212, v212
    v_lshlrev_b32 v148, 16, v148
    v_exp_f32 v213, v213
    v_lshlrev_b32 v149, 16, v149
    v_exp_f32 v214, v214
    v_lshlrev_b32 v150, 16, v150
    v_exp_f32 v215, v215
    v_lshlrev_b32 v151, 16, v151
    v_exp_f32 v216, v216
    v_lshlrev_b32 v152, 16, v152
    v_exp_f32 v217, v217
    v_lshlrev_b32 v153, 16, v153
    v_pk_add_f32 v[228:229], v[192:193], v[194:195]
    v_pk_mul_f32 v[230:231], v[192:193], v[128:129]
    v_pk_fma_f32 v[230:231], v[194:195], v[130:131], v[230:231]
    v_pk_add_f32 v[228:229], v[228:229], v[196:197]
    v_pk_fma_f32 v[230:231], v[196:197], v[132:133], v[230:231]
    v_pk_add_f32 v[228:229], v[228:229], v[198:199]
    v_pk_fma_f32 v[230:231], v[198:199], v[134:135], v[230:231]
    v_pk_add_f32 v[228:229], v[228:229], v[200:201]
    v_pk_fma_f32 v[230:231], v[200:201], v[136:137], v[230:231]
    v_pk_add_f32 v[228:229], v[228:229], v[202:203]
    v_pk_fma_f32 v[230:231], v[202:203], v[138:139], v[230:231]
    v_pk_add_f32 v[228:229], v[228:229], v[204:205]
    v_pk_fma_f32 v[230:231], v[204:205], v[140:141], v[230:231]
    v_pk_add_f32 v[228:229], v[228:229], v[206:207]
    v_pk_fma_f32 v[230:231], v[206:207], v[142:143], v[230:231]
    v_pk_add_f32 v[228:229], v[228:229], v[208:209]
    v_pk_fma_f32 v[230:231], v[208:209], v[144:145], v[230:231]
    v_pk_add_f32 v[228:229], v[228:229], v[210:211]
    v_pk_fma_f32 v[230:231], v[210:211], v[146:147], v[230:231]
    v_pk_add_f32 v[228:229], v[228:229], v[212:213]
    v_pk_fma_f32 v[230:231], v[212:213], v[148:149], v[230:231]
    v_pk_add_f32 v[228:229], v[228:229], v[214:215]
    v_pk_fma_f32 v[230:231], v[214:215], v[150:151], v[230:231]
    v_pk_add_f32 v[228:229], v[228:229], v[216:217]
    v_pk_fma_f32 v[230:231], v[216:217], v[152:153], v[230:231]
    v_add_f32 v225, v228, v229
    v_add_f32 v226, v230, v231
    v_mov_b32 v227, 0
    v_lshlrev_b32 v16, 4, v104
    buffer_store_dwordx4 v[224:227], v16, s[36:39], 0 offen sc1
    s_mov_b64 exec, s[80:81]
afm_tab_kernel_sl_k2:
    v_xor_b32 v16, s40, v235
    v_cmp_gt_u32 vcc, 4, v16
    s_cbranch_vccz afm_tab_kernel_sl_k3
    s_and_saveexec_b64 s[80:81], vcc
    s_add_u32 s46, s62, 3
    v_add_u32 v104, s46, v91
    v_mul_hi_u32 v112, v104, s41
    v_lshlrev_b32 v114, 2, v104
    v_mul_u32_u24 v113, 26, v112
    v_mul_u32_u24 v112, 104, v112
    v_sub_u32 v108, v104, v113
    buffer_load_dword v106, v114, s[56:59], 0 offen
    buffer_load_dwordx4 v[128:131], v112, s[56:59], 0 offen offset:0
    buffer_load_dwordx4 v[132:135], v112, s[56:59], 0 offen offset:16
    buffer_load_dwordx4 v[136:139], v112, s[56:59], 0 offen offset:32
    buffer_load_dwordx4 v[140:143], v112, s[56:59], 0 offen offset:48
    buffer_load_dwordx4 v[144:147], v112, s[56:59], 0 offen offset:64
    buffer_load_dwordx4 v[148:151], v112, s[56:59], 0 offen offset:80
    buffer_load_dwordx2 v[152:153], v112, s[56:59], 0 offen offset:96
    s_waitcnt vmcnt(0)
    v_and_b32 v112, 3, v106
    v_sub_u32 v114, s43, v112
    v_mul_u32_u24 v112, 2052, v112
    v_add_u32 v112, 147712, v112
    v_cmp_le_u32 s[64:65], 0, v108
    v_cmp_le_u32 s[66:67], 1, v108
    v_cmp_le_u32 s[68:69], 2, v108
    v_subb_co_u32 v128, vcc, v128, v106, s[64:65]
    v_add_u32 v113, s42, v128
    v_min_u32 v128, v128, v113
    v_addc_co_u32 v128, vcc, 0, v128, s[64:65]
    v_min_u32 v128, v114, v128
    v_lshl_add_u32 v128, v128, 2, v112
    v_cmp_le_u32 s[70:71], 3, v108
    v_subb_co_u32 v129, vcc, v129, v106, s[66:67]
    v_add_u32 v113, s42, v129
    v_min_u32 v129, v129, v113
    v_addc_co_u32 v129, vcc, 0, v129, s[66:67]
    v_min_u32 v129, v114, v129
    v_lshl_add_u32 v129, v129, 2, v112
    v_cmp_le_u32 s[64:65], 4, v108
    v_subb_co_u32 v130, vcc, v130, v106, s[68:69]
    v_add_u32 v113, s42, v130
    v_min_u32 v130, v130, v113
    v_addc_co_u32 v130, vcc, 0, v130, s[68:69]
    v_min_u32 v130, v114, v130
    v_lshl_add_u32 v130, v130, 2, v112
    v_cmp_le_u32 s[66:67], 5, v108
    v_subb_co_u32 v131, vcc, v131, v106, s[70:71]
    v_add_u32 v113, s42, v131
    v_min_u32 v131, v131, v113
    v_addc_co_u32 v131, vcc, 0, v131, s[70:71]
    v_min_u32 v131, v114, v131
    v_lshl_add_u32 v131, v131, 2, v112
    v_cmp_le_u32 s[68:69], 6, v108
    v_subb_co_u32 v132, vcc, v132, v106, s[64:65]
    v_add_u32 v113, s42, v132
    v_min_u32 v132, v132, v113
    v_addc_co_u32 v132, vcc, 0, v132, s[64:65]
    v_min_u32 v132, v114, v132
    v_lshl_add_u32 v132, v132, 2, v112
    v_cmp_le_u32 s[70:71], 7, v108
    v_subb_co_u32 v133, vcc, v133, v106, s[66:67]
    v_add_u32 v113, s42, v133
    v_min_u32 v133, v133, v113
    v_addc_co_u32 v133, vcc, 0, v133, s[66:67]
    v_min_u32 v133, v114, v133
    v_lshl_add_u32 v133, v133, 2, v112
    v_cmp_le_u32 s[64:65], 8, v108
    v_subb_co_u32 v134, vcc, v134, v106, s[68:69]
    v_add_u32 v113, s42, v134
    v_min_u32 v134, v134, v113
    v_addc_co_u32 v134, vcc, 0, v134, s[68:69]
    v_min_u32 v134, v114, v134
    v_lshl_add_u32 v134, v134, 2, v112
    v_cmp_le_u32 s[66:67], 9, v108
    v_subb_co_u32 v135, vcc, v135, v106, s[70:71]
    v_add_u32 v113, s42, v135
    v_min_u32 v135, v135, v113
    v_addc_co_u32 v135, vcc, 0, v135, s[70:71]
    v_min_u32 v135, v114, v135
    v_lshl_add_u32 v135, v135, 2, v112
    v_cmp_le_u32 s[68:69], 10, v108
    v_subb_co_u32 v136, vcc, v136, v106, s[64:65]
    v_add_u32 v113, s42, v136
    v_min_u32 v136, v136, v113
    v_addc_co_u32 v136, vcc, 0, v136, s[64:65]
    v_min_u32 v136, v114, v136
    v_lshl_add_u32 v136, v136, 2, v112
    v_cmp_le_u32 s[70:71], 11, v108
    v_subb_co_u32 v137, vcc, v137, v106, s[66:67]
    v_add_u32 v113, s42, v137
    v_min_u32 v137, v137, v113
    v_addc_co_u32 v137, vcc, 0, v137, s[66:67]
    v_min_u32 v137, v114, v137
    v_lshl_add_u32 v137, v137, 2, v112
    v_cmp_le_u32 s[64:65], 12, v108
    v_subb_co_u32 v138, vcc, v138, v106, s[68:69]
    v_add_u32 v113, s42, v138
    v_min_u32 v138, v138, v113
    v_addc_co_u32 v138, vcc, 0, v138, s[68:69]
    v_min_u32 v138, v114, v138
    v_lshl_add_u32 v138, v138, 2, v112
    v_cmp_le_u32 s[66:67], 13, v108
    v_subb_co_u32 v139, vcc, v139, v106, s[70:71]
    v_add_u32 v113, s42, v139
    v_min_u32 v139, v139, v113
    v_addc_co_u32 v139, vcc, 0, v139, s[70:71]
    v_min_u32 v139, v114, v139
    v_lshl_add_u32 v139, v139, 2, v112
    v_cmp_le_u32 s[68:69], 14, v108
    v_subb_co_u32 v140, vcc, v140, v106, s[64:65]
    v_add_u32 v113, s42, v140
    v_min_u32 v140, v140, v113
    v_addc_co_u32 v140, vcc, 0, v140, s[64:65]
    v_min_u32 v140, v114, v140
    v_lshl_add_u32 v140, v140, 2, v112
    v_cmp_le_u32 s[70:71], 15, v108
    v_subb_co_u32 v141, vcc, v141, v106, s[66:67]
    v_add_u32 v113, s42, v141
    v_min_u32 v141, v141, v113
    v_addc_co_u32 v141, vcc, 0, v141, s[66:67]
    v_min_u32 v141, v114, v141
    v_lshl_add_u32 v141, v141, 2, v112
    v_cmp_le_u32 s[64:65], 16, v108
    v_subb_co_u32 v142, vcc, v142, v106, s[68:69]
    v_add_u32 v113, s42, v142
    v_min_u32 v142, v142, v113
    v_addc_co_u32 v142, vcc, 0, v142, s[68:69]
    v_min_u32 v142, v114, v142
    v_lshl_add_u32 v142, v142, 2, v112
    v_cmp_le_u32 s[66:67], 17, v108
    v_subb_co_u32 v143, vcc, v143, v106, s[70:71]
    v_add_u32 v113, s42, v143
    v_min_u32 v143, v143, v113
    v_addc_co_u32 v143, vcc, 0, v143, s[70:71]
    v_min_u32 v143, v114, v143
    v_lshl_add_u32 v143, v143, 2, v112
    v_cmp_le_u32 s[68:69], 18, v108
    v_subb_co_u32 v144, vcc, v144, v106, s[64:65]
    v_add_u32 v113, s42, v144
    v_min_u32 v144, v144, v113
    v_addc_co_u32 v144, vcc, 0, v144, s[64:65]
    v_min_u32 v144, v114, v144
    v_lshl_add_u32 v144, v144, 2, v112
    v_cmp_le_u32 s[70:71], 19, v108
    v_subb_co_u32 v145, vcc, v145, v106, s[66:67]
    v_add_u32 v113, s42, v145
    v_min_u32 v145, v145, v113
    v_addc_co_u32 v145, vcc, 0, v145, s[66:67]
    v_min_u32 v145, v114, v145
    v_lshl_add_u32 v145, v145, 2, v112
    v_cmp_le_u32 s[64:65], 20, v108
    v_subb_co_u32 v146, vcc, v146, v106, s[68:69]
    v_add_u32 v113, s42, v146
    v_min_u32 v146, v146, v113
    v_addc_co_u32 v146, vcc, 0, v146, s[68:69]
    v_min_u32 v146, v114, v146
    v_lshl_add_u32 v146, v146, 2, v112
    v_cmp_le_u32 s[66:67], 21, v108
    v_subb_co_u32 v147, vcc, v147, v106, s[70:71]
    v_add_u32 v113, s42, v147
    v_min_u32 v147, v147, v113
    v_addc_co_u32 v147, vcc, 0, v147, s[70:71]
    v_min_u32 v147, v114, v147
    v_lshl_add_u32 v147, v147, 2, v112
    v_cmp_le_u32 s[68:69], 22, v108
    v_subb_co_u32 v148, vcc, v148, v106, s[64:65]
    v_add_u32 v113, s42, v148
    v_min_u32 v148, v148, v113
    v_addc_co_u32 v148, vcc, 0, v148, s[64:65]
    v_min_u32 v148, v114, v148
    v_lshl_add_u32 v148, v148, 2, v112
    v_cmp_le_u32 s[70:71], 23, v108
    v_subb_co_u32 v149, vcc, v149, v106, s[66:67]
    v_add_u32 v113, s42, v149
    v_min_u32 v149, v149, v113
    v_addc_co_u32 v149, vcc, 0, v149, s[66:67]
    v_min_u32 v149, v114, v149
    v_lshl_add_u32 v149, v149, 2, v112
    v_cmp_le_u32 s[64:65], 24, v108
    v_subb_co_u32 v150, vcc, v150, v106, s[68:69]
    v_add_u32 v113, s42, v150
    v_min_u32 v150, v150, v113
    v_addc_co_u32 v150, vcc, 0, v150, s[68:69]
    v_min_u32 v150, v114, v150
    v_lshl_add_u32 v150, v150, 2, v112
    v_cmp_le_u32 s[66:67], 25, v108
    v_subb_co_u32 v151, vcc, v151, v106, s[70:71]
    v_add_u32 v113, s42, v151
    v_min_u32 v151, v151, v113
    v_addc_co_u32 v151, vcc, 0, v151, s[70:71]
    v_min_u32 v151, v114, v151
    v_lshl_add_u32 v151, v151, 2, v112
    v_subb_co_u32 v152, vcc, v152, v106, s[64:65]
    v_add_u32 v113, s42, v152
    v_min_u32 v152, v152, v113
    v_addc_co_u32 v152, vcc, 0, v152, s[64:65]
    v_min_u32 v152, v114, v152
    v_lshl_add_u32 v152, v152, 2, v112
    v_subb_co_u32 v153, vcc, v153, v106, s[66:67]
    v_add_u32 v113, s42, v153
    v_min_u32 v153, v153, v113
    v_addc_co_u32 v153, vcc, 0, v153, s[66:67]
    v_min_u32 v153, v114, v153
    v_lshl_add_u32 v153, v153, 2, v112
    ds_read_b32 v128, v128
    ds_read_b32 v129, v129
    ds_read_b32 v130, v130
    ds_read_b32 v131, v131
    ds_read_b32 v132, v132
    ds_read_b32 v133, v133
    ds_read_b32 v134, v134
    ds_read_b32 v135, v135
    ds_read_b32 v136, v136
    ds_read_b32 v137, v137
    ds_read_b32 v138, v138
    ds_read_b32 v139, v139
    ds_read_b32 v140, v140
    ds_read_b32 v141, v141
    ds_read_b32 v142, v142
    s_waitcnt lgkmcnt(4)
    ds_read_b32 v143, v143
    ds_read_b32 v144, v144
    ds_read_b32 v145, v145
    ds_read_b32 v146, v146
    ds_read_b32 v147, v147
    ds_read_b32 v148, v148
    ds_read_b32 v149, v149
    ds_read_b32 v150, v150
    ds_read_b32 v151, v151
    ds_read_b32 v152, v152
    ds_read_b32 v153, v153
    s_waitcnt lgkmcnt(0)
    v_max3_f32 v224, v128, v129, s45
    v_max3_f32 v224, v224, v130, v131
    v_max3_f32 v224, v224, v132, v133
    v_max3_f32 v224, v224, v134, v135
    v_max3_f32 v224, v224, v136, v137
    v_max3_f32 v224, v224, v138, v139
    v_max3_f32 v224, v224, v140, v141
    v_max3_f32 v224, v224, v142, v143
    v_max3_f32 v224, v224, v144, v145
    v_max3_f32 v224, v224, v146, v147
    v_max3_f32 v224, v224, v148, v149
    v_max3_f32 v224, v224, v150, v151
    v_max3_f32 v224, v224, v152, v153
    v_and_b32 v224, 0xffff0000, v224
    v_xor_b32 v227, 0x80000000, v224
    s_nop 1
    v_dot2_f32_bf16 v192, v128, s44, v227
    v_dot2_f32_bf16 v193, v129, s44, v227
    v_dot2_f32_bf16 v194, v130, s44, v227
    v_dot2_f32_bf16 v195, v131, s44, v227
    v_dot2_f32_bf16 v196, v132, s44, v227
    v_dot2_f32_bf16 v197, v133, s44, v227
    v_dot2_f32_bf16 v198, v134, s44, v227
    v_dot2_f32_bf16 v199, v135, s44, v227
    v_dot2_f32_bf16 v200, v136, s44, v227
    v_dot2_f32_bf16 v201, v137, s44, v227
    v_dot2_f32_bf16 v202, v138, s44, v227
    v_dot2_f32_bf16 v203, v139, s44, v227
    v_dot2_f32_bf16 v204, v140, s44, v227
    v_dot2_f32_bf16 v205, v141, s44, v227
    v_dot2_f32_bf16 v206, v142, s44, v227
    v_dot2_f32_bf16 v207, v143, s44, v227
    v_dot2_f32_bf16 v208, v144, s44, v227
    v_dot2_f32_bf16 v209, v145, s44, v227
    v_dot2_f32_bf16 v210, v146, s44, v227
    v_dot2_f32_bf16 v211, v147, s44, v227
    v_dot2_f32_bf16 v212, v148, s44, v227
    v_dot2_f32_bf16 v213, v149, s44, v227
    v_dot2_f32_bf16 v214, v150, s44, v227
    v_dot2_f32_bf16 v215, v151, s44, v227
    v_dot2_f32_bf16 v216, v152, s44, v227
    v_dot2_f32_bf16 v217, v153, s44, v227
    s_nop 2
    v_exp_f32 v192, v192
    v_lshlrev_b32 v128, 16, v128
    v_exp_f32 v193, v193
    v_lshlrev_b32 v129, 16, v129
    v_exp_f32 v194, v194
    v_lshlrev_b32 v130, 16, v130
    v_exp_f32 v195, v195
    v_lshlrev_b32 v131, 16, v131
    v_exp_f32 v196, v196
    v_lshlrev_b32 v132, 16, v132
    v_exp_f32 v197, v197
    v_lshlrev_b32 v133, 16, v133
    v_exp_f32 v198, v198
    v_lshlrev_b32 v134, 16, v134
    v_exp_f32 v199, v199
    v_lshlrev_b32 v135, 16, v135
    v_exp_f32 v200, v200
    v_lshlrev_b32 v136, 16, v136
    v_exp_f32 v201, v201
    v_lshlrev_b32 v137, 16, v137
    v_exp_f32 v202, v202
    v_lshlrev_b32 v138, 16, v138
    v_exp_f32 v203, v203
    v_lshlrev_b32 v139, 16, v139
    v_exp_f32 v204, v204
    v_lshlrev_b32 v140, 16, v140
    v_exp_f32 v205, v205
    v_lshlrev_b32 v141, 16, v141
    v_exp_f32 v206, v206
    v_lshlrev_b32 v142, 16, v142
    v_exp_f32 v207, v207
    v_lshlrev_b32 v143, 16, v143
    v_exp_f32 v208, v208
    v_lshlrev_b32 v144, 16, v144
    v_exp_f32 v209, v209
    v_lshlrev_b32 v145, 16, v145
    v_exp_f32 v210, v210
    v_lshlrev_b32 v146, 16, v146
    v_exp_f32 v211, v211
    v_lshlrev_b32 v147, 16, v147
    v_exp_f32 v212, v212
    v_lshlrev_b32 v148, 16, v148
    v_exp_f32 v213, v213
    v_lshlrev_b32 v149, 16, v149
    v_exp_f32 v214, v214
    v_lshlrev_b32 v150, 16, v150
    v_exp_f32 v215, v215
    v_lshlrev_b32 v151, 16, v151
    v_exp_f32 v216, v216
    v_lshlrev_b32 v152, 16, v152
    v_exp_f32 v217, v217
    v_lshlrev_b32 v153, 16, v153
    v_pk_add_f32 v[228:229], v[192:193], v[194:195]
    v_pk_mul_f32 v[230:231], v[192:193], v[128:129]
    v_pk_fma_f32 v[230:231], v[194:195], v[130:131], v[230:231]
    v_pk_add_f32 v[228:229], v[228:229], v[196:197]
    v_pk_fma_f32 v[230:231], v[196:197], v[132:133], v[230:231]
    v_pk_add_f32 v[228:229], v[228:229], v[198:199]
    v_pk_fma_f32 v[230:231], v[198:199], v[134:135], v[230:231]
    v_pk_add_f32 v[228:229], v[228:229], v[200:201]
    v_pk_fma_f32 v[230:231], v[200:201], v[136:137], v[230:231]
    v_pk_add_f32 v[228:229], v[228:229], v[202:203]
    v_pk_fma_f32 v[230:231], v[202:203], v[138:139], v[230:231]
    v_pk_add_f32 v[228:229], v[228:229], v[204:205]
    v_pk_fma_f32 v[230:231], v[204:205], v[140:141], v[230:231]
    v_pk_add_f32 v[228:229], v[228:229], v[206:207]
    v_pk_fma_f32 v[230:231], v[206:207], v[142:143], v[230:231]
    v_pk_add_f32 v[228:229], v[228:229], v[208:209]
    v_pk_fma_f32 v[230:231], v[208:209], v[144:145], v[230:231]
    v_pk_add_f32 v[228:229], v[228:229], v[210:211]
    v_pk_fma_f32 v[230:231], v[210:211], v[146:147], v[230:231]
    v_pk_add_f32 v[228:229], v[228:229], v[212:213]
    v_pk_fma_f32 v[230:231], v[212:213], v[148:149], v[230:231]
    v_pk_add_f32 v[228:229], v[228:229], v[214:215]
    v_pk_fma_f32 v[230:231], v[214:215], v[150:151], v[230:231]
    v_pk_add_f32 v[228:229], v[228:229], v[216:217]
    v_pk_fma_f32 v[230:231], v[216:217], v[152:153], v[230:231]
    v_add_f32 v225, v228, v229
    v_add_f32 v226, v230, v231
    v_mov_b32 v227, 0
    v_lshlrev_b32 v16, 4, v104
    buffer_store_dwordx4 v[224:227], v16, s[36:39], 0 offen sc1
    s_mov_b64 exec, s[80:81]
afm_tab_kernel_sl_k3:
    s_add_u32 s60, s60, 1024
    s_add_u32 s62, s62, 256
    s_add_u32 s51, s51, 1
    s_cmp_lt_u32 s51, 104
    s_cbranch_scc1 afm_tab_kernel_sl_g
    s_branch afm_tab_kernel_end
afm_tab_kernel_prod:
    s_load_dwordx2 s[8:9], s[0:1], 72
    v_lshlrev_b32 v3, 2, v1
    v_mov_b32 v4, 0
    s_cmp_ge_u32 s3, 4
    s_cbranch_scc1 afm_tab_kernel_pz
    ds_write_b32 v3, v4
afm_tab_kernel_pz:
    s_mov_b32 s61, 17758
    s_cmp_eq_u32 s41, 5
    s_cselect_b32 s61, 17706, s61
    v_mov_b32 v5, 1
    v_mov_b32 v6, 1000
    s_waitcnt lgkmcnt(0)
    s_barrier
    s_waitcnt vmcnt(8)
    v_and_b32 v68, -4, v16
    ds_add_rtn_u32 v60, v68, v5
    v_and_b32 v69, -4, v17
    ds_add_rtn_u32 v61, v69, v5
    v_and_b32 v70, -4, v18
    ds_add_rtn_u32 v62, v70, v5
    v_and_b32 v71, -4, v19
    ds_add_rtn_u32 v63, v71, v5
    s_waitcnt vmcnt(7)
    v_and_b32 v72, -4, v20
    ds_add_rtn_u32 v64, v72, v5
    v_and_b32 v73, -4, v21
    ds_add_rtn_u32 v65, v73, v5
    v_and_b32 v74, -4, v22
    ds_add_rtn_u32 v66, v74, v5
    v_and_b32 v75, -4, v23
    ds_add_rtn_u32 v67, v75, v5
    s_waitcnt lgkmcnt(4)
    v_min_u32 v60, 127, v60
    v_mul_u32_u24 v68, 65, v68
    v_lshl_add_u32 v68, v60, 1, v68
    v_add_u32 v60, 0, v3
    ds_write_b16 v68, v60 offset:1024
    v_min_u32 v61, 127, v61
    v_mul_u32_u24 v69, 65, v69
    v_lshl_add_u32 v69, v61, 1, v69
    v_add_u32 v61, 1, v3
    ds_write_b16 v69, v61 offset:1024
    v_min_u32 v62, 127, v62
    v_mul_u32_u24 v70, 65, v70
    v_lshl_add_u32 v70, v62, 1, v70
    v_add_u32 v62, 2, v3
    ds_write_b16 v70, v62 offset:1024
    v_min_u32 v63, 127, v63
    v_mul_u32_u24 v71, 65, v71
    v_lshl_add_u32 v71, v63, 1, v71
    v_add_u32 v63, 3, v3
    ds_write_b16 v71, v63 offset:1024
    s_waitcnt vmcnt(6)
    v_and_b32 v68, -4, v24
    ds_add_rtn_u32 v60, v68, v5
    v_and_b32 v69, -4, v25
    ds_add_rtn_u32 v61, v69, v5
    v_and_b32 v70, -4, v26
    ds_add_rtn_u32 v62, v70, v5
    v_and_b32 v71, -4, v27
    ds_add_rtn_u32 v63, v71, v5
    s_waitcnt lgkmcnt(8)
    v_min_u32 v64, 127, v64
    v_mul_u32_u24 v72, 65, v72
    v_lshl_add_u32 v72, v64, 1, v72
    v_add_u32 v64, 2048, v3
    ds_write_b16 v72, v64 offset:1024
    v_min_u32 v65, 127, v65
    v_mul_u32_u24 v73, 65, v73
    v_lshl_add_u32 v73, v65, 1, v73
    v_add_u32 v65, 2049, v3
    ds_write_b16 v73, v65 offset:1024
    v_min_u32 v66, 127, v66
    v_mul_u32_u24 v74, 65, v74
    v_lshl_add_u32 v74, v66, 1, v74
    v_add_u32 v66, 2050, v3
    ds_write_b16 v74, v66 offset:1024
    v_min_u32 v67, 127, v67
    v_mul_u32_u24 v75, 65, v75
    v_lshl_add_u32 v75, v67, 1, v75
    v_add_u32 v67, 2051, v3
    ds_write_b16 v75, v67 offset:1024
    s_waitcnt vmcnt(5)
    v_and_b32 v72, -4, v28
    ds_add_rtn_u32 v64, v72, v5
    v_and_b32 v73, -4, v29
    ds_add_rtn_u32 v65, v73, v5
    v_and_b32 v74, -4, v30
    ds_add_rtn_u32 v66, v74, v5
    v_and_b32 v75, -4, v31
    ds_add_rtn_u32 v67, v75, v5
    s_waitcnt lgkmcnt(8)
    v_min_u32 v60, 127, v60
    v_mul_u32_u24 v68, 65, v68
    v_lshl_add_u32 v68, v60, 1, v68
    v_add_u32 v60, 4096, v3
    ds_write_b16 v68, v60 offset:1024
    v_min_u32 v61, 127, v61
    v_mul_u32_u24 v69, 65, v69
    v_lshl_add_u32 v69, v61, 1, v69
    v_add_u32 v61, 4097, v3
    ds_write_b16 v69, v61 offset:1024
    v_min_u32 v62, 127, v62
    v_mul_u32_u24 v70, 65, v70
    v_lshl_add_u32 v70, v62, 1, v70
    v_add_u32 v62, 4098, v3
    ds_write_b16 v70, v62 offset:1024
    v_min_u32 v63, 127, v63
    v_mul_u32_u24 v71, 65, v71
    v_lshl_add_u32 v71, v63, 1, v71
    v_add_u32 v63, 4099, v3
    ds_write_b16 v71, v63 offset:1024
    s_waitcnt vmcnt(4)
    v_and_b32 v68, -4, v32
    ds_add_rtn_u32 v60, v68, v5
    v_and_b32 v69, -4, v33
    ds_add_rtn_u32 v61, v69, v5
    v_and_b32 v70, -4, v34
    ds_add_rtn_u32 v62, v70, v5
    v_and_b32 v71, -4, v35
    ds_add_rtn_u32 v63, v71, v5
    s_waitcnt lgkmcnt(8)
    v_min_u32 v64, 127, v64
    v_mul_u32_u24 v72, 65, v72
    v_lshl_add_u32 v72, v64, 1, v72
    v_add_u32 v64, 6144, v3
    ds_write_b16 v72, v64 offset:1024
    v_min_u32 v65, 127, v65
    v_mul_u32_u24 v73, 65, v73
    v_lshl_add_u32 v73, v65, 1, v73
    v_add_u32 v65, 6145, v3
    ds_write_b16 v73, v65 offset:1024
    v_min_u32 v66, 127, v66
    v_mul_u32_u24 v74, 65, v74
    v_lshl_add_u32 v74, v66, 1, v74
    v_add_u32 v66, 6146, v3
    ds_write_b16 v74, v66 offset:1024
    v_min_u32 v67, 127, v67
    v_mul_u32_u24 v75, 65, v75
    v_lshl_add_u32 v75, v67, 1, v75
    v_add_u32 v67, 6147, v3
    ds_write_b16 v75, v67 offset:1024
    s_waitcnt vmcnt(3)
    v_and_b32 v72, -4, v36
    ds_add_rtn_u32 v64, v72, v5
    v_and_b32 v73, -4, v37
    ds_add_rtn_u32 v65, v73, v5
    v_and_b32 v74, -4, v38
    ds_add_rtn_u32 v66, v74, v5
    v_and_b32 v75, -4, v39
    ds_add_rtn_u32 v67, v75, v5
    s_waitcnt lgkmcnt(8)
    v_min_u32 v60, 127, v60
    v_mul_u32_u24 v68, 65, v68
    v_lshl_add_u32 v68, v60, 1, v68
    v_add_u32 v60, 8192, v3
    ds_write_b16 v68, v60 offset:1024
    v_min_u32 v61, 127, v61
    v_mul_u32_u24 v69, 65, v69
    v_lshl_add_u32 v69, v61, 1, v69
    v_add_u32 v61, 8193, v3
    ds_write_b16 v69, v61 offset:1024
    v_min_u32 v62, 127, v62
    v_mul_u32_u24 v70, 65, v70
    v_lshl_add_u32 v70, v62, 1, v70
    v_add_u32 v62, 8194, v3
    ds_write_b16 v70, v62 offset:1024
    v_min_u32 v63, 127, v63
    v_mul_u32_u24 v71, 65, v71
    v_lshl_add_u32 v71, v63, 1, v71
    v_add_u32 v63, 8195, v3
    ds_write_b16 v71, v63 offset:1024
    s_waitcnt vmcnt(2)
    v_and_b32 v68, -4, v40
    ds_add_rtn_u32 v60, v68, v5
    v_and_b32 v69, -4, v41
    ds_add_rtn_u32 v61, v69, v5
    v_and_b32 v70, -4, v42
    ds_add_rtn_u32 v62, v70, v5
    v_and_b32 v71, -4, v43
    ds_add_rtn_u32 v63, v71, v5
    s_waitcnt lgkmcnt(8)
    v_min_u32 v64, 127, v64
    v_mul_u32_u24 v72, 65, v72
    v_lshl_add_u32 v72, v64, 1, v72
    v_add_u32 v64, 10240, v3
    ds_write_b16 v72, v64 offset:1024
    v_min_u32 v65, 127, v65
    v_mul_u32_u24 v73, 65, v73
    v_lshl_add_u32 v73, v65, 1, v73
    v_add_u32 v65, 10241, v3
    ds_write_b16 v73, v65 offset:1024
    v_min_u32 v66, 127, v66
    v_mul_u32_u24 v74, 65, v74
    v_lshl_add_u32 v74, v66, 1, v74
    v_add_u32 v66, 10242, v3
    ds_write_b16 v74, v66 offset:1024
    v_min_u32 v67, 127, v67
    v_mul_u32_u24 v75, 65, v75
    v_lshl_add_u32 v75, v67, 1, v75
    v_add_u32 v67, 10243, v3
    ds_write_b16 v75, v67 offset:1024
    s_waitcnt vmcnt(1)
    v_and_b32 v72, -4, v44
    ds_add_rtn_u32 v64, v72, v5
    v_and_b32 v73, -4, v45
    ds_add_rtn_u32 v65, v73, v5
    v_and_b32 v74, -4, v46
    ds_add_rtn_u32 v66, v74, v5
    v_and_b32 v75, -4, v47
    ds_add_rtn_u32 v67, v75, v5
    s_waitcnt lgkmcnt(8)
    v_min_u32 v60, 127, v60
    v_mul_u32_u24 v68, 65, v68
    v_lshl_add_u32 v68, v60, 1, v68
    v_add_u32 v60, 12288, v3
    ds_write_b16 v68, v60 offset:1024
    v_min_u32 v61, 127, v61
    v_mul_u32_u24 v69, 65, v69
    v_lshl_add_u32 v69, v61, 1, v69
    v_add_u32 v61, 12289, v3
    ds_write_b16 v69, v61 offset:1024
    v_min_u32 v62, 127, v62
    v_mul_u32_u24 v70, 65, v70
    v_lshl_add_u32 v70, v62, 1, v70
    v_add_u32 v62, 12290, v3
    ds_write_b16 v70, v62 offset:1024
    v_min_u32 v63, 127, v63
    v_mul_u32_u24 v71, 65, v71
    v_lshl_add_u32 v71, v63, 1, v71
    v_add_u32 v63, 12291, v3
    ds_write_b16 v71, v63 offset:1024
    s_waitcnt vmcnt(0)
    v_add_u32 v8, 16384, v3
    v_cmp_gt_u32 vcc, s61, v8
    s_nop 1
    v_cndmask_b32 v48, v6, v48, vcc
    v_and_b32 v68, -4, v48
    ds_add_rtn_u32 v60, v68, v5
    v_add_u32 v8, 16385, v3
    v_cmp_gt_u32 vcc, s61, v8
    s_nop 1
    v_cndmask_b32 v49, v6, v49, vcc
    v_and_b32 v69, -4, v49
    ds_add_rtn_u32 v61, v69, v5
    v_add_u32 v8, 16386, v3
    v_cmp_gt_u32 vcc, s61, v8
    s_nop 1
    v_cndmask_b32 v50, v6, v50, vcc
    v_and_b32 v70, -4, v50
    ds_add_rtn_u32 v62, v70, v5
    v_add_u32 v8, 16387, v3
    v_cmp_gt_u32 vcc, s61, v8
    s_nop 1
    v_cndmask_b32 v51, v6, v51, vcc
    v_and_b32 v71, -4, v51
    ds_add_rtn_u32 v63, v71, v5
    s_waitcnt lgkmcnt(8)
    v_min_u32 v64, 127, v64
    v_mul_u32_u24 v72, 65, v72
    v_lshl_add_u32 v72, v64, 1, v72
    v_add_u32 v64, 14336, v3
    ds_write_b16 v72, v64 offset:1024
    v_min_u32 v65, 127, v65
    v_mul_u32_u24 v73, 65, v73
    v_lshl_add_u32 v73, v65, 1, v73
    v_add_u32 v65, 14337, v3
    ds_write_b16 v73, v65 offset:1024
    v_min_u32 v66, 127, v66
    v_mul_u32_u24 v74, 65, v74
    v_lshl_add_u32 v74, v66, 1, v74
    v_add_u32 v66, 14338, v3
    ds_write_b16 v74, v66 offset:1024
    v_min_u32 v67, 127, v67
    v_mul_u32_u24 v75, 65, v75
    v_lshl_add_u32 v75, v67, 1, v75
    v_add_u32 v67, 14339, v3
    ds_write_b16 v75, v67 offset:1024
    s_waitcnt lgkmcnt(4)
    v_min_u32 v60, 127, v60
    v_mul_u32_u24 v68, 65, v68
    v_lshl_add_u32 v68, v60, 1, v68
    v_add_u32 v60, 16384, v3
    ds_write_b16 v68, v60 offset:1024
    v_min_u32 v61, 127, v61
    v_mul_u32_u24 v69, 65, v69
    v_lshl_add_u32 v69, v61, 1, v69
    v_add_u32 v61, 16385, v3
    ds_write_b16 v69, v61 offset:1024
    v_min_u32 v62, 127, v62
    v_mul_u32_u24 v70, 65, v70
    v_lshl_add_u32 v70, v62, 1, v70
    v_add_u32 v62, 16386, v3
    ds_write_b16 v70, v62 offset:1024
    v_min_u32 v63, 127, v63
    v_mul_u32_u24 v71, 65, v71
    v_lshl_add_u32 v71, v63, 1, v71
    v_add_u32 v63, 16387, v3
    ds_write_b16 v71, v63 offset:1024
    s_mov_b32 s36, s6
    s_mov_b32 s37, s7
    s_mov_b32 s38, 0x10000000
    s_mov_b32 s39, 0x00020000
    s_mul_i32 s60, s41, 65536
    s_add_u32 s60, s60, 2097152
    s_lshl_b32 s62, s41, 10
    s_add_u32 s62, s62, 3145728
    s_waitcnt lgkmcnt(0)
    s_barrier
    ds_read_b128 v[16:19], v2 offset:1024
    ds_read_b128 v[20:23], v2 offset:9216
    ds_read_b128 v[24:27], v2 offset:17408
    ds_read_b128 v[28:31], v2 offset:25600
    ds_read_b128 v[32:35], v2 offset:33792
    ds_read_b128 v[36:39], v2 offset:41984
    ds_read_b128 v[40:43], v2 offset:50176
    ds_read_b128 v[44:47], v2 offset:58368
    s_cmp_ge_u32 s3, 4
    s_cbranch_scc1 afm_tab_kernel_pc
    ds_read_b32 v8, v3
    s_waitcnt lgkmcnt(0)
    buffer_store_dword v8, v3, s[36:39], s62 offen sc1
afm_tab_kernel_pc:
    s_waitcnt lgkmcnt(7)
    buffer_store_dwordx4 v[16:19], v2, s[36:39], s60 offen sc1
    s_add_u32 s60, s60, 8192
    s_waitcnt lgkmcnt(6)
    buffer_store_dwordx4 v[20:23], v2, s[36:39], s60 offen sc1
    s_add_u32 s60, s60, 8192
    s_waitcnt lgkmcnt(5)
    buffer_store_dwordx4 v[24:27], v2, s[36:39], s60 offen sc1
    s_add_u32 s60, s60, 8192
    s_waitcnt lgkmcnt(4)
    buffer_store_dwordx4 v[28:31], v2, s[36:39], s60 offen sc1
    s_add_u32 s60, s60, 8192
    s_waitcnt lgkmcnt(3)
    buffer_store_dwordx4 v[32:35], v2, s[36:39], s60 offen sc1
    s_add_u32 s60, s60, 8192
    s_waitcnt lgkmcnt(2)
    buffer_store_dwordx4 v[36:39], v2, s[36:39], s60 offen sc1
    s_add_u32 s60, s60, 8192
    s_waitcnt lgkmcnt(1)
    buffer_store_dwordx4 v[40:43], v2, s[36:39], s60 offen sc1
    s_add_u32 s60, s60, 8192
    s_waitcnt lgkmcnt(0)
    buffer_store_dwordx4 v[44:47], v2, s[36:39], s60 offen sc1
    s_waitcnt vmcnt(0)
    s_barrier
    s_cmp_lg_u32 s3, 0
    s_cbranch_scc1 afm_tab_kernel_end
    s_mov_b32 s10, 256
    s_mov_b32 s11, 0x00020000
    v_lshlrev_b32 v8, 6, v0
    s_mov_b64 exec, 15
    buffer_atomic_add v5, v8, s[8:11], 0 offen
    s_mov_b64 exec, -1
    s_branch afm_tab_kernel_end
afm_tab_kernel_end:
afm_tab_kernel_done:
    s_endpgm
.p2align 8
.type afm_out_kernel,@function
afm_out_kernel:
    s_cmp_ge_u32 s2, 512
    s_cbranch_scc1 afm_out_kernel_done
    s_load_dwordx2 s[4:5], s[0:1], 80
    s_load_dwordx2 s[6:7], s[0:1], 64
    v_lshrrev_b32 v1, 6, v0
    v_and_b32 v0, 63, v0
    v_readfirstlane_b32 s3, v1
    v_lshrrev_b32 v2, 5, v0
    v_and_b32 v3, 31, v0
    s_mul_i32 s8, s2, 4
    s_add_u32 s8, s8, s3
    s_mul_i32 s9, s8, 2
    v_mul_u32_u24 v4, 26, v2
    v_add_u32 v4, v4, v3
    v_lshlrev_b32 v4, 4, v4
    s_mul_i32 s10, s9, 416
    v_mov_b32 v8, 0xf149f2ca
    v_mov_b32 v9, 0
    v_mov_b32 v10, 0
    v_cmp_gt_u32 vcc, 26, v3
    s_waitcnt lgkmcnt(0)
    s_mov_b32 s12, s4
    s_mov_b32 s13, s5
    s_mov_b32 s14, 1703936
    s_mov_b32 s15, 0x00020000
    s_and_saveexec_b64 s[20:21], vcc
    buffer_load_dwordx3 v[8:10], v4, s[12:15], s10 offen offset:0
    s_mov_b64 exec, s[20:21]
    s_mov_b32 s16, s6
    s_mov_b32 s17, s7
    s_mov_b32 s18, 8192
    s_mov_b32 s19, 0x00020000
    s_lshl_b32 s10, s9, 1
    v_lshlrev_b32 v5, 1, v2
    v_add_u32 v5, s10, v5
    v_cmp_eq_u32 s[22:23], 0, v3
    s_waitcnt vmcnt(0)
    v_mov_b32 v24, v8
    s_nop 1
    v_max_f32_dpp v24, v24, v24 row_ror:8 row_mask:0xf bank_mask:0xf
    s_nop 1
    v_max_f32_dpp v24, v24, v24 row_ror:4 row_mask:0xf bank_mask:0xf
    s_nop 1
    v_max_f32_dpp v24, v24, v24 row_ror:2 row_mask:0xf bank_mask:0xf
    s_nop 1
    v_max_f32_dpp v24, v24, v24 row_ror:1 row_mask:0xf bank_mask:0xf
    s_nop 1
    v_mov_b32 v40, v24
    s_nop 1
    v_permlane16_swap_b32 v24, v40
    v_max_f32 v24, v24, v40
    v_sub_f32 v8, v8, v24
    v_exp_f32 v8, v8
    s_nop 0
    v_mul_f32 v24, v9, v8
    v_mul_f32 v25, v10, v8
    s_nop 1
    v_add_f32_dpp v24, v24, v24 row_ror:8 row_mask:0xf bank_mask:0xf
    v_add_f32_dpp v25, v25, v25 row_ror:8 row_mask:0xf bank_mask:0xf
    s_nop 0
    v_add_f32_dpp v24, v24, v24 row_ror:4 row_mask:0xf bank_mask:0xf
    v_add_f32_dpp v25, v25, v25 row_ror:4 row_mask:0xf bank_mask:0xf
    s_nop 0
    v_add_f32_dpp v24, v24, v24 row_ror:2 row_mask:0xf bank_mask:0xf
    v_add_f32_dpp v25, v25, v25 row_ror:2 row_mask:0xf bank_mask:0xf
    s_nop 0
    v_add_f32_dpp v24, v24, v24 row_ror:1 row_mask:0xf bank_mask:0xf
    v_add_f32_dpp v25, v25, v25 row_ror:1 row_mask:0xf bank_mask:0xf
    s_nop 0
    v_mov_b32 v40, v24
    v_mov_b32 v41, v25
    s_nop 1
    v_permlane16_swap_b32 v24, v40
    v_permlane16_swap_b32 v25, v41
    v_add_f32 v24, v24, v40
    v_add_f32 v25, v25, v41
    v_rcp_f32 v24, v24
    s_nop 0
    v_mul_f32 v24, v24, v25
    v_cvt_pk_bf16_f32 v24, v24, v24
    s_mov_b64 exec, s[22:23]
    buffer_store_short v24, v5, s[16:19], 0 offen offset:0
afm_out_kernel_done:
    s_endpgm
.section .rodata,"a"
.p2align 6
.amdhsa_kernel afm_tab_kernel
  .amdhsa_next_free_vgpr 256
  .amdhsa_next_free_sgpr 102
  .amdhsa_accum_offset 256
  .amdhsa_group_segment_fixed_size 0
  .amdhsa_kernarg_size 88
  .amdhsa_user_sgpr_count 2
  .amdhsa_user_sgpr_kernarg_segment_ptr 1
  .amdhsa_system_sgpr_workgroup_id_x 1
.end_amdhsa_kernel
.p2align 6
.amdhsa_kernel afm_out_kernel
  .amdhsa_next_free_vgpr 64
  .amdhsa_next_free_sgpr 48
  .amdhsa_accum_offset 64
  .amdhsa_group_segment_fixed_size 0
  .amdhsa_kernarg_size 88
  .amdhsa_user_sgpr_count 2
  .amdhsa_user_sgpr_kernarg_segment_ptr 1
  .amdhsa_system_sgpr_workgroup_id_x 1
.end_amdhsa_kernel
```
